```python
import torch

def _softmax(x, axis=-1):
    return torch.softmax(x, dim=axis)
def _gelu(x):
    return torch.nn.functional.gelu(x, approximate="tanh")
def _silu(x):
    return torch.nn.functional.silu(x)
def _sigmoid(x):
    return torch.sigmoid(x)
def _layernorm(x, axis=-1, eps=1e-5):
    m = x.mean(dim=axis, keepdim=True)
    v = x.var(dim=axis, keepdim=True, unbiased=False)
    return (x - m) / torch.sqrt(v + eps)
def _scatter_add(tgt, idx, src, axis=0):
    return tgt.clone().index_add_(axis, idx, src)
def _segment_sum(src, seg, n):
    out = torch.zeros((n,) + src.shape[1:], dtype=src.dtype)
    return out.index_add_(0, seg, src)
def _pad(x, pw):
    flat = tuple(v for pair in reversed(pw) for v in pair)
    return torch.nn.functional.pad(x, flat)

kernel_name = 'gated_mix__linear_kernel_hedgehog__sliding_block__prompt'

def setup_inputs():

    _w = (lambda a: (lambda t: t.to(torch.bfloat16) if t.is_floating_point() else t)(torch.as_tensor(a)))
    def _A_setup():
        B, S, D, H = 1, 2048, 512, 32
        Dh = D // H
        return {
            "x": _w((lambda *s: torch.randn(*s, dtype=torch.bfloat16) * 0.05)(B, S, D)),
            "wqkv": _w((lambda *s: torch.randn(*s, dtype=torch.bfloat16) * 1.6)(D, 3 * D)),
            "w_phi": _w((lambda *s: torch.randn(*s, dtype=torch.bfloat16) * 1.6)(H, Dh, Dh) * (Dh ** -0.5)),
            "wo": _w((lambda *s: torch.randn(*s, dtype=torch.bfloat16) * 0.1)(D, D)),
        }
    _A_in = _A_setup()

    def _B_setup():
        B, S, D = 1, 2048, 512
        return {
            "x": _w((lambda *s: torch.randn(*s, dtype=torch.bfloat16) * 0.05)(B, S, D)),
            "wqkv": _w((lambda *s: torch.randn(*s, dtype=torch.bfloat16) * 0.8)(D, 3 * D)),
            "wo": _w((lambda *s: torch.randn(*s, dtype=torch.bfloat16) * 0.05)(D, D)),
        }
    _B_in = _B_setup()

    return {
        "A_x": _A_in["x"],
        "A_wqkv": _A_in["wqkv"],
        "A_w_phi": _A_in["w_phi"],
        "A_wo": _A_in["wo"],
        "B_x": _B_in["x"],
        "B_wqkv": _B_in["wqkv"],
        "B_wo": _B_in["wo"],
        "gate_w": _w((lambda *s: torch.randn(*s, dtype=torch.bfloat16) * 0.05)(512) * 16.0),
    }

def reference(A_x, A_wqkv, A_w_phi, A_wo, B_x, B_wqkv, B_wo, gate_w):
    def _A_ref(x, wqkv, w_phi, wo):
        B, S, D = x.shape
        H = 32; Dh = D // H
        qkv = (lambda x, *d: x.permute(*d))((x @ wqkv).reshape(B, S, 3, H, Dh), 2, 0, 3, 1, 4)
        q, k, v = qkv[0], qkv[1], qkv[2]
        pq = torch.einsum("bhsd,hdf->bhsf", q, w_phi)
        pk = torch.einsum("bhsd,hdf->bhsf", k, w_phi)
        phi_q = torch.concatenate([_softmax(pq, axis=-1), _softmax(-pq, axis=-1)], axis=-1)
        phi_k = torch.concatenate([_softmax(pk, axis=-1), _softmax(-pk, axis=-1)], axis=-1)
        kv = torch.einsum("bhsf,bhsd->bhfd", phi_k, v)
        z  = torch.einsum("bhsf->bhf", phi_k)
        num = torch.einsum("bhqf,bhfd->bhqd", phi_q, kv)
        den = torch.einsum("bhqf,bhf->bhq", phi_q, z)[..., None] + 1e-6
        o = num / den
        return (lambda x, *d: x.permute(*d))(o, 0, 2, 1, 3).reshape(B, S, D) @ wo

    def _B_ref(x, wqkv, wo):
        B, S, D = x.shape
        H = 32; Dh = D // H; W = 256
        qkv = (lambda x, *d: x.permute(*d))((x @ wqkv).reshape(B, S, 3, H, Dh), 2, 0, 3, 1, 4)
        q, k, v = qkv[0], qkv[1], qkv[2]
        scores = torch.einsum("bhqd,bhkd->bhqk", q, k) * (Dh ** -0.5)
        idx = torch.arange(S)
        mask = (idx[:, None] - idx[None, :] >= 0) & (idx[:, None] - idx[None, :] < W)
        scores = torch.where(mask[None, None], scores, -1e9)
        p = _softmax(scores, axis=-1)
        o = torch.einsum("bhqk,bhkd->bhqd", p, v)
        return (lambda x, *d: x.permute(*d))(o, 0, 2, 1, 3).reshape(B, S, D) @ wo

    x = A_x
    g = _sigmoid((x * gate_w).sum(-1, keepdims=True))
    a = _A_ref(x, A_wqkv, A_w_phi, A_wo)
    b = _B_ref(x, B_wqkv, B_wo)
    return g * a + (1 - g) * b
```

```asm
; @launch grid=(256,1,1) block=(512,1,1) lds=163840
.amdgcn_target "amdgcn-amd-amdhsa--gfx950"
.text
.globl gated_mix__linear_kernel_hedgehog__sliding_block__prompt_kernel
.p2align 8
.type gated_mix__linear_kernel_hedgehog__sliding_block__prompt_kernel,@function
gated_mix__linear_kernel_hedgehog__sliding_block__prompt_kernel:
  s_load_dwordx16 s[4:19], s[0:1], 0
  s_load_dwordx4 s[20:23], s[0:1], 64
  s_load_dwordx2 s[36:37], s[0:1], 80
  s_cmp_ge_u32 s2, 256
  s_cbranch_scc1 L_exit
  v_readfirstlane_b32 s55, v0
  s_getpc_b64 s[26:27]
  v_min_u32 v2, 187, v0
  v_lshlrev_b32 v2, 7, v2
  s_nop 0
  s_lshr_b32 s55, s55, 6
  s_cmp_ge_u32 s55, 4
  s_cbranch_scc1 L_producer
  global_load_dword v53, v2, s[26:27]
  s_mov_b64 exec, 0
  s_cmp_eq_u32 s55, 1
  s_cbranch_scc1 L_pad2
  s_cmp_eq_u32 s55, 2
  s_cbranch_scc1 L_pad3
  s_cmp_eq_u32 s55, 3
  s_cbranch_scc1 L_pad4
  s_branch L_pad1
L_producer:
  v_and_b32 v1, 63, v0
  s_bfe_u32 s52, s2, 0x30003
  s_bfe_u32 s54, s2, 0x10006
  s_lshr_b32 s66, s2, 7
  s_and_b32 s53, s2, 7
  s_lshl_b32 s66, s66, 3
  s_add_u32 s52, s52, s66
  s_add_u32 s59, s53, s52
  s_and_b32 s59, s59, 7
  s_sub_u32 s44, s55, 4
  v_lshrrev_b32 v4, 3, v1
  v_and_b32 v5, 7, v1
  v_lshrrev_b32 v6, 4, v1
  v_xor_b32 v7, v5, v6
  s_lshl_b32 s65, s52, 7
  s_lshl_b32 s66, s44, 5
  s_add_u32 s65, s65, s66
  v_add_u32 v8, s65, v4
  v_lshlrev_b32 v8, 10, v8
  v_lshl_add_u32 v16, v7, 4, v8
  v_xor_b32 v17, 64, v16
  v_add_u32 v17, 0x2000, v17
  v_add_u32 v18, 0x4000, v16
  v_add_u32 v19, 0x4000, v17
  v_and_b32 v9, 1, v6
  v_lshlrev_b32 v9, 2, v9
  v_xor_b32 v9, v5, v9
  s_lshl_b32 s66, s44, 4
  v_add_u32 v8, s66, v4
  v_mul_u32_u24 v8, 3072, v8
  v_lshl_add_u32 v8, v9, 4, v8
L_pad1:
  s_cbranch_execz L_pad5
  s_mul_i32 s66, s54, 4
  s_xor_b32 s66, s66, s53
  s_lshl_b32 s66, s66, 7
  s_add_u32 s66, s66, 1024
  v_add_u32 v20, s66, v8
  v_xor_b32 v21, 32, v20
  v_add_u32 v21, 24576, v21
  v_add_u32 v22, 1024, v20
  v_add_u32 v23, 1024, v21
  s_lshl_b32 s70, s44, 12
  s_lshl_b32 s71, s44, 11
  s_mov_b32 s26, 0x200000
  s_mov_b32 s27, 0x20000
  s_mov_b32 s42, 0x180000
  s_mov_b32 s43, 0x20000
  s_cmp_eq_u32 s54, 1
  s_waitcnt lgkmcnt(0)
  s_mov_b32 s24, s4
  s_mov_b32 s25, s5
  s_cselect_b32 s40, s14, s6
  s_cselect_b32 s41, s15, s7
  s_xor_b32 s74, s59, 0
L_pad2:
  s_cbranch_execz L_pad6
  s_lshl_b32 s75, s74, 7
  s_mul_i32 s76, s74, 196608
  s_add_u32 m0, s70, 0
  s_nop 0
  buffer_load_dwordx4 v16, s[24:27], s75 offen lds
  s_add_u32 m0, s70, 1024
  s_nop 0
  buffer_load_dwordx4 v17, s[24:27], s75 offen lds
  s_add_u32 m0, s70, 2048
  s_nop 0
  buffer_load_dwordx4 v18, s[24:27], s75 offen lds
  s_add_u32 m0, s70, 3072
  s_nop 0
  buffer_load_dwordx4 v19, s[24:27], s75 offen lds
  s_add_u32 m0, s71, 16384
  s_nop 0
  buffer_load_dwordx4 v20, s[40:43], s76 offen lds
  s_add_u32 m0, s71, 17408
  s_nop 0
  buffer_load_dwordx4 v21, s[40:43], s76 offen lds
L_pad3:
  s_cbranch_execz L_pad7
  s_add_u32 m0, s71, 24576
  s_nop 0
  buffer_load_dwordx4 v22, s[40:43], s76 offen lds
  s_add_u32 m0, s71, 25600
  s_nop 0
  buffer_load_dwordx4 v23, s[40:43], s76 offen lds
  v_lshlrev_b32 v2, 4, v1
  v_mov_b32 v15, 0
  s_and_b32 s66, s44, 1
  s_lshl_b32 s66, s66, 10
  s_lshl_b32 s67, s53, 11
  s_add_u32 s67, s67, s66
  s_add_u32 s80, s8, s67
  s_addc_u32 s81, s9, 0
  s_add_u32 m0, s66, 161792
  s_nop 0
  global_load_lds_dwordx4 v2, s[80:81]
  s_xor_b32 s74, s59, 1
  s_lshl_b32 s75, s74, 7
  s_mul_i32 s76, s74, 196608
  s_add_u32 m0, s70, 32768
  s_nop 0
  buffer_load_dwordx4 v16, s[24:27], s75 offen lds
L_pad4:
  s_cbranch_execz L_pad8
  s_add_u32 m0, s70, 33792
  s_nop 0
  buffer_load_dwordx4 v17, s[24:27], s75 offen lds
  s_add_u32 m0, s70, 34816
  s_nop 0
  buffer_load_dwordx4 v18, s[24:27], s75 offen lds
  s_add_u32 m0, s70, 35840
  s_nop 0
  buffer_load_dwordx4 v19, s[24:27], s75 offen lds
  v_and_b32 v3, 31, v1
  v_lshrrev_b32 v6, 5, v1
  v_bfe_u32 v7, v1, 4, 1
  v_bfe_u32 v11, v1, 2, 2
  v_lshl_add_u32 v9, v6, 2, v11
  v_and_b32 v10, 3, v1
  v_lshlrev_b32 v0, 3, v3
  s_mov_b32 s38, 0x1000000
  s_mov_b32 s39, 0x20000
L_pad5:
  s_cbranch_execz L_pad9
  s_mov_b32 s60, 0xffff
  s_mov_b32 s61, 0xffff
  s_and_b32 s57, s55, 1
  s_bfe_u32 s58, s55, 0x10001
  s_getreg_b32 s63, hwreg(HW_REG_XCC_ID, 0, 4)
  s_lshl_b32 s3, s53, 8
  s_add_u32 s3, s3, 0x960000
  s_mov_b64 s[18:19], s[10:11]
  s_mov_b64 s[20:21], s[16:17]
  s_lshl_b32 s65, s53, 1
  s_add_u32 s65, s65, s57
  s_lshl_b32 s66, s65, 5
  s_add_u32 s66, s66, s52
  s_lshl_b32 s66, s66, 1
  s_add_u32 s66, s66, s58
  s_lshl_b32 s14, s66, 12
  s_add_u32 s14, s14, 0x4000
  s_lshl_b32 s65, s65, 4
  s_add_u32 s65, s65, s52
  s_lshl_b32 s65, s65, 1
  s_add_u32 s65, s65, s58
  s_lshl_b32 s15, s65, 7
  s_add_u32 s15, s15, 0x900000
  s_lshl_b32 s69, s53, 1
  s_add_u32 s69, s69, s57
L_pad6:
  s_cbranch_execz L_pad10
  s_lshl_b32 s69, s69, 1
  s_add_u32 s69, s69, s58
  s_lshl_b32 s67, s69, 4
  s_add_u32 s67, s67, s52
  s_lshl_b32 s17, s67, 7
  s_add_u32 s17, s17, 0x920000
  s_mul_i32 s16, s69, 18432
  s_lshl_b32 s66, s52, 10
  s_add_u32 s16, s16, s66
  s_add_u32 s16, s16, 0x820000
  s_mul_i32 s68, s52, 896
  s_sub_u32 s68, 16384, s68
  s_add_u32 s11, s16, s68
  v_lshrrev_b32 v5, 1, v3
  v_and_b32 v5, 7, v5
  v_xor_b32 v5, v5, v6
  v_lshlrev_b32 v5, 4, v5
  v_lshl_add_u32 v5, v3, 7, v5
  v_add_u32 v24, s70, v5
  v_xor_b32 v25, 32, v24
  v_xor_b32 v26, 64, v24
  v_xor_b32 v27, 96, v24
  v_add_u32 v28, 0x10000, v24
L_pad7:
  s_cbranch_execz L_pad11
  v_add_u32 v29, 0x10000, v25
  v_add_u32 v30, 0x10000, v26
  v_add_u32 v31, 0x10000, v27
  v_add_u32 v64, 0x20000, v24
  v_add_u32 v65, 0x20000, v25
  v_add_u32 v66, 0x20000, v26
  v_add_u32 v67, 0x20000, v27
  v_subrev_u32 v32, 1024, v20
  v_add_u32 v33, 24576, v32
  v_lshl_add_u32 v4, v6, 3, v11
  v_lshlrev_b32 v4, 7, v4
  v_lshrrev_b32 v5, 1, v11
  v_lshl_add_u32 v4, v5, 6, v4
  v_lshl_add_u32 v4, v7, 5, v4
  v_lshl_add_u32 v4, v10, 3, v4
  v_add_u32 v34, 98304, v4
  v_xor_b32 v35, 64, v34
L_pad8:
  s_cbranch_execz L_pad12
  s_add_u32 s72, s71, 98304
  s_add_u32 s66, s71, 49152
  v_add_u32 v44, s66, v2
  v_and_b32 v5, 15, v1
  v_lshlrev_b32 v5, 4, v5
  v_lshl_add_u32 v5, v6, 8, v5
  s_add_u32 s66, s66, 1024
  v_add_u32 v45, s66, v5
  s_lshl_b32 s65, s52, 2
  s_add_u32 s65, s65, s44
  s_min_u32 s6, s65, 8
  s_lshl_b32 s66, s53, 1
  s_sub_u32 s66, s66, s54
  s_add_u32 s66, s66, 1
  s_lshl_b32 s66, s66, 7
  s_add_u32 s66, s66, s65
  s_lshl_b32 s12, s66, 11
  s_add_u32 s12, s12, 0x4000
  s_mov_b32 s13, 0x4e800000
  s_lshl_b32 s66, s65, 4
  s_add_u32 s66, s66, s53
  s_lshl_b32 s32, s66, 12
  s_add_u32 s32, s32, 0x410000
  s_lshl_b32 s33, s66, 9
L_pad9:
  s_cbranch_execz L_consumer
  s_add_u32 s33, s33, 0x980000
  s_lshl_b32 s66, s65, 3
  s_add_u32 s66, s66, s53
  s_lshl_b32 s7, s66, 11
  s_add_u32 s7, s7, 0xa00000
  s_lshl_b32 s8, s66, 7
  s_add_u32 s8, s8, 0x8c0000
  s_lshl_b32 s65, s65, 4
  s_xor_b32 s66, s53, 4
  s_add_u32 s65, s65, s66
  s_lshl_b32 s65, s65, 1
  s_sub_u32 s65, s65, s54
  s_add_u32 s65, s65, 17
  s_lshl_b32 s4, s65, 11
  s_add_u32 s4, s4, 0x410000
  s_lshl_b32 s5, s65, 8
  s_add_u32 s5, s5, 0x980000
  s_cmp_eq_u32 s54, 1
  s_mov_b32 s10, 0x3fb8aa3b
  s_cselect_b32 s10, 0x3eb8aa3b, s10
  s_cselect_b32 s65, s8, s17
  s_cselect_b32 s66, s15, s11
  s_mov_b32 s28, 0x300ff
L_pad10:
  s_cbranch_execz L_consumer
  s_cselect_b32 s28, 0x3ffff, s28
  s_mov_b32 s29, 0
  s_cselect_b32 s64, s7, s16
  v_lshl_add_u32 v36, v1, 7, s64
  v_writelane_b32 v36, s65, 16
  v_writelane_b32 v36, s66, 17
  v_lshlrev_b32 v4, 5, v9
  v_lshl_add_u32 v4, v10, 3, v4
  v_add_u32 v39, 161792, v4
  v_lshlrev_b32 v40, 15, v7
  v_lshl_or_b32 v40, v7, 31, v40
  s_lshl_b32 s64, s44, 2
  s_add_u32 s64, s64, 113664
  v_lshl_add_u32 v8, v1, 14, s64
  s_lshl_b32 s64, s52, 2
  s_add_u32 s64, s64, s44
  s_lshl_b32 s65, s53, 3
  s_add_u32 s64, s64, s65
  s_and_b32 s64, s64, 63
  s_lshl_b32 s64, s64, 13
  v_lshl_add_u32 v7, v1, 7, s64
L_pad11:
  s_cbranch_execz L_consumer
  v_lshlrev_b32 v4, 3, v6
  v_sub_u32 v47, v3, v4
  v_mov_b32 v38, 0xf149f2ca
  s_add_u32 m0, s71, 49152
  s_nop 0
  buffer_load_dwordx4 v20, s[40:43], s76 offen lds
  s_add_u32 m0, s71, 50176
  s_nop 0
  buffer_load_dwordx4 v21, s[40:43], s76 offen lds
  s_add_u32 m0, s71, 57344
  s_nop 0
  buffer_load_dwordx4 v22, s[40:43], s76 offen lds
  s_add_u32 m0, s71, 58368
  s_nop 0
  buffer_load_dwordx4 v23, s[40:43], s76 offen lds
  s_waitcnt vmcnt(8)
  s_barrier
  ds_read_b128 v[128:131], v24 offset:0
  ds_read_b128 v[132:135], v25 offset:0
  ds_read_b128 v[136:139], v26 offset:0
L_pad12:
  s_cbranch_execz L_consumer
  ds_read_b128 v[140:143], v27 offset:0
  ds_read_b64_tr_b16 v[48:49], v39 offset:0
  ds_read_b64_tr_b16 v[50:51], v39 offset:256
  ds_read_b64_tr_b16 v[52:53], v39 offset:512
  ds_read_b64_tr_b16 v[54:55], v39 offset:768
  ds_read_b64_tr_b16 v[56:57], v39 offset:1024
  ds_read_b64_tr_b16 v[58:59], v39 offset:1280
  ds_read_b64_tr_b16 v[60:61], v39 offset:1536
  ds_read_b64_tr_b16 v[62:63], v39 offset:1792
  global_load_dword v14, v15, s[22:23] sc1
  s_xor_b32 s74, s59, 2
  s_lshl_b32 s75, s74, 7
  s_mul_i32 s76, s74, 196608
  s_add_u32 m0, s70, 65536
  s_nop 0
  buffer_load_dwordx4 v16, s[24:27], s75 offen lds
  s_add_u32 m0, s70, 66560
  s_nop 0
  buffer_load_dwordx4 v17, s[24:27], s75 offen lds
  s_add_u32 m0, s70, 67584
  s_nop 0
  buffer_load_dwordx4 v18, s[24:27], s75 offen lds
  s_add_u32 m0, s70, 68608
  s_nop 0
  buffer_load_dwordx4 v19, s[24:27], s75 offen lds
  s_add_u32 m0, s71, 81920
  s_nop 0
  buffer_load_dwordx4 v20, s[40:43], s76 offen lds
  s_add_u32 m0, s71, 82944
  s_nop 0
  buffer_load_dwordx4 v21, s[40:43], s76 offen lds
  s_add_u32 m0, s71, 90112
  s_nop 0
  buffer_load_dwordx4 v22, s[40:43], s76 offen lds
  s_add_u32 m0, s71, 91136
  s_nop 0
  buffer_load_dwordx4 v23, s[40:43], s76 offen lds
  s_mov_b64 exec, s[28:29]
  buffer_load_dword v10, v36, s[36:39], 0 offen sc1
  s_mov_b64 exec, -1
  s_waitcnt lgkmcnt(0)
  s_waitcnt vmcnt(10)
  s_barrier
  ds_read_b128 v[144:147], v24 offset:32768
  ds_read_b128 v[148:151], v25 offset:32768
  ds_read_b128 v[152:155], v26 offset:32768
  ds_read_b128 v[156:159], v27 offset:32768
  s_xor_b32 s74, s59, 3
  s_lshl_b32 s75, s74, 7
  s_mul_i32 s76, s74, 196608
  s_add_u32 m0, s70, 98304
  s_nop 0
  buffer_load_dwordx4 v16, s[24:27], s75 offen lds
  v_xor_b32 v48, v40, v48
  v_xor_b32 v49, v40, v49
  v_xor_b32 v50, v40, v50
  s_add_u32 m0, s70, 99328
  s_nop 0
  buffer_load_dwordx4 v17, s[24:27], s75 offen lds
  v_xor_b32 v51, v40, v51
  v_cmp_le_i32 vcc, 0, v47
  s_nop 1
  v_cndmask_b32_e64 v96, v38, 0, vcc
  s_add_u32 m0, s70, 100352
  s_nop 0
  buffer_load_dwordx4 v18, s[24:27], s75 offen lds
  v_cndmask_b32_e64 v112, 0, v38, vcc
  v_cmp_le_i32 vcc, 1, v47
  s_nop 1
  v_cndmask_b32_e64 v97, v38, 0, vcc
  s_add_u32 m0, s70, 101376
  s_nop 0
  buffer_load_dwordx4 v19, s[24:27], s75 offen lds
  v_cndmask_b32_e64 v113, 0, v38, vcc
  v_cmp_le_i32 vcc, 2, v47
  s_nop 1
  v_cndmask_b32_e64 v98, v38, 0, vcc
  s_add_u32 m0, s71, 114688
  s_nop 0
  buffer_load_dwordx4 v20, s[40:43], s76 offen lds
  v_cndmask_b32_e64 v114, 0, v38, vcc
  v_cmp_le_i32 vcc, 3, v47
  s_nop 1
  v_cndmask_b32_e64 v99, v38, 0, vcc
  s_add_u32 m0, s71, 115712
  s_nop 0
  buffer_load_dwordx4 v21, s[40:43], s76 offen lds
  v_cndmask_b32_e64 v115, 0, v38, vcc
  s_add_u32 m0, s71, 122880
  s_nop 0
  buffer_load_dwordx4 v22, s[40:43], s76 offen lds
  s_add_u32 m0, s71, 123904
  s_nop 0
  buffer_load_dwordx4 v23, s[40:43], s76 offen lds
  s_waitcnt lgkmcnt(0)
  s_waitcnt vmcnt(9)
  s_barrier
  ds_read_b128 v[160:163], v28 offset:0
  ds_read_b128 v[164:167], v29 offset:0
  ds_read_b128 v[168:171], v30 offset:0
  ds_read_b128 v[172:175], v31 offset:0
  s_xor_b32 s74, s59, 4
  s_lshl_b32 s75, s74, 7
  s_mul_i32 s76, s74, 196608
  s_add_u32 m0, s70, 131072
  s_nop 0
  buffer_load_dwordx4 v16, s[24:27], s75 offen lds
  v_xor_b32 v52, v40, v52
  s_add_u32 m0, s70, 132096
  s_nop 0
  buffer_load_dwordx4 v17, s[24:27], s75 offen lds
  v_xor_b32 v53, v40, v53
  s_add_u32 m0, s70, 133120
  s_nop 0
  buffer_load_dwordx4 v18, s[24:27], s75 offen lds
  v_xor_b32 v54, v40, v54
  s_add_u32 m0, s70, 134144
  s_nop 0
  buffer_load_dwordx4 v19, s[24:27], s75 offen lds
  v_xor_b32 v55, v40, v55
  s_add_u32 m0, s71, 147456
  s_nop 0
  buffer_load_dwordx4 v20, s[40:43], s76 offen lds
  s_add_u32 m0, s71, 148480
  s_nop 0
  buffer_load_dwordx4 v21, s[40:43], s76 offen lds
  s_add_u32 m0, s71, 155648
  s_nop 0
  buffer_load_dwordx4 v22, s[40:43], s76 offen lds
  s_add_u32 m0, s71, 156672
  s_nop 0
  buffer_load_dwordx4 v23, s[40:43], s76 offen lds
  v_readfirstlane_b32 s56, v14
  s_nop 3
  s_cmp_eq_u32 s56, 0
  s_cbranch_scc1 L_gn0
L_gn0_ok:
  s_lshl_b32 s65, s54, 4
  s_add_u32 s65, s65, s52
  s_lshl_b32 s65, s65, 3
  s_add_u32 s65, s65, s3
  v_mov_b32 v4, s63
  v_mov_b32 v5, s56
  s_cmp_lg_u32 s44, 0
  s_cbranch_scc1 L_nox
  s_mov_b64 exec, 1
  buffer_store_dwordx2 v[4:5], v15, s[36:39], s65 offen sc1
  s_mov_b64 exec, -1
L_nox:
  s_waitcnt lgkmcnt(0)
  s_waitcnt vmcnt(8)
  s_barrier
  ds_read_b128 v[176:179], v28 offset:32768
  ds_read_b128 v[180:183], v29 offset:32768
  ds_read_b128 v[184:187], v30 offset:32768
  ds_read_b128 v[188:191], v31 offset:32768
  s_xor_b32 s74, s59, 5
  s_lshl_b32 s75, s74, 7
  s_mul_i32 s76, s74, 196608
  s_add_u32 m0, s70, 0
  s_nop 0
  buffer_load_dwordx4 v16, s[24:27], s75 offen lds
  v_xor_b32 v56, v40, v56
  v_xor_b32 v57, v40, v57
  v_xor_b32 v58, v40, v58
  s_add_u32 m0, s70, 1024
  s_nop 0
  buffer_load_dwordx4 v17, s[24:27], s75 offen lds
  v_xor_b32 v59, v40, v59
  v_cmp_le_i32 vcc, 4, v47
  s_nop 1
  v_cndmask_b32_e64 v100, v38, 0, vcc
  s_add_u32 m0, s70, 2048
  s_nop 0
  buffer_load_dwordx4 v18, s[24:27], s75 offen lds
  v_cndmask_b32_e64 v116, 0, v38, vcc
  v_cmp_le_i32 vcc, 5, v47
  s_nop 1
  v_cndmask_b32_e64 v101, v38, 0, vcc
  s_add_u32 m0, s70, 3072
  s_nop 0
  buffer_load_dwordx4 v19, s[24:27], s75 offen lds
  v_cndmask_b32_e64 v117, 0, v38, vcc
  v_cmp_le_i32 vcc, 6, v47
  s_nop 1
  v_cndmask_b32_e64 v102, v38, 0, vcc
  s_add_u32 m0, s71, 16384
  s_nop 0
  buffer_load_dwordx4 v20, s[40:43], s76 offen lds
  v_cndmask_b32_e64 v118, 0, v38, vcc
  v_cmp_le_i32 vcc, 7, v47
  s_nop 1
  v_cndmask_b32_e64 v103, v38, 0, vcc
  s_add_u32 m0, s71, 17408
  s_nop 0
  buffer_load_dwordx4 v21, s[40:43], s76 offen lds
  v_cndmask_b32_e64 v119, 0, v38, vcc
  s_add_u32 m0, s71, 24576
  s_nop 0
  buffer_load_dwordx4 v22, s[40:43], s76 offen lds
  s_add_u32 m0, s71, 25600
  s_nop 0
  buffer_load_dwordx4 v23, s[40:43], s76 offen lds
  s_waitcnt lgkmcnt(0)
  s_waitcnt vmcnt(8)
  s_barrier
  ds_read_b128 v[192:195], v64 offset:0
  ds_read_b128 v[196:199], v65 offset:0
  ds_read_b128 v[200:203], v66 offset:0
  ds_read_b128 v[204:207], v67 offset:0
  s_xor_b32 s74, s59, 6
  s_lshl_b32 s75, s74, 7
  s_mul_i32 s76, s74, 196608
  s_add_u32 m0, s70, 32768
  s_nop 0
  buffer_load_dwordx4 v16, s[24:27], s75 offen lds
  v_xor_b32 v60, v40, v60
  s_add_u32 m0, s70, 33792
  s_nop 0
  buffer_load_dwordx4 v17, s[24:27], s75 offen lds
  v_xor_b32 v61, v40, v61
  s_add_u32 m0, s70, 34816
  s_nop 0
  buffer_load_dwordx4 v18, s[24:27], s75 offen lds
  v_xor_b32 v62, v40, v62
  s_add_u32 m0, s70, 35840
  s_nop 0
  buffer_load_dwordx4 v19, s[24:27], s75 offen lds
  v_xor_b32 v63, v40, v63
  s_add_u32 m0, s71, 49152
  s_nop 0
  buffer_load_dwordx4 v20, s[40:43], s76 offen lds
  s_add_u32 m0, s71, 50176
  s_nop 0
  buffer_load_dwordx4 v21, s[40:43], s76 offen lds
  s_add_u32 m0, s71, 57344
  s_nop 0
  buffer_load_dwordx4 v22, s[40:43], s76 offen lds
  s_add_u32 m0, s71, 58368
  s_nop 0
  buffer_load_dwordx4 v23, s[40:43], s76 offen lds
  s_waitcnt lgkmcnt(0)
  s_waitcnt vmcnt(8)
  s_barrier
  ds_read_b128 v[208:211], v24 offset:0
  ds_read_b128 v[212:215], v25 offset:0
  ds_read_b128 v[216:219], v26 offset:0
  ds_read_b128 v[220:223], v27 offset:0
  s_xor_b32 s74, s59, 7
  s_lshl_b32 s75, s74, 7
  s_mul_i32 s76, s74, 196608
  s_add_u32 m0, s70, 65536
  s_nop 0
  buffer_load_dwordx4 v16, s[24:27], s75 offen lds
  v_cmp_le_i32 vcc, 16, v47
  s_nop 1
  v_cndmask_b32_e64 v104, v38, 0, vcc
  s_add_u32 m0, s70, 66560
  s_nop 0
  buffer_load_dwordx4 v17, s[24:27], s75 offen lds
  v_cndmask_b32_e64 v120, 0, v38, vcc
  v_cmp_le_i32 vcc, 17, v47
  s_add_u32 m0, s70, 67584
  s_nop 0
  buffer_load_dwordx4 v18, s[24:27], s75 offen lds
  v_cndmask_b32_e64 v105, v38, 0, vcc
  v_cndmask_b32_e64 v121, 0, v38, vcc
  s_add_u32 m0, s70, 68608
  s_nop 0
  buffer_load_dwordx4 v19, s[24:27], s75 offen lds
  v_cmp_le_i32 vcc, 18, v47
  s_nop 1
  v_cndmask_b32_e64 v106, v38, 0, vcc
  s_add_u32 m0, s71, 81920
  s_nop 0
  buffer_load_dwordx4 v20, s[40:43], s76 offen lds
  v_cndmask_b32_e64 v122, 0, v38, vcc
  v_cmp_le_i32 vcc, 19, v47
  s_add_u32 m0, s71, 82944
  s_nop 0
  buffer_load_dwordx4 v21, s[40:43], s76 offen lds
  v_cndmask_b32_e64 v107, v38, 0, vcc
  v_cndmask_b32_e64 v123, 0, v38, vcc
  s_add_u32 m0, s71, 90112
  s_nop 0
  buffer_load_dwordx4 v22, s[40:43], s76 offen lds
  s_add_u32 m0, s71, 91136
  s_nop 0
  buffer_load_dwordx4 v23, s[40:43], s76 offen lds
  s_waitcnt lgkmcnt(0)
  s_waitcnt vmcnt(8)
  s_barrier
  ds_read_b128 v[224:227], v24 offset:32768
  ds_read_b128 v[228:231], v25 offset:32768
  ds_read_b128 v[232:235], v26 offset:32768
  ds_read_b128 v[236:239], v27 offset:32768
  buffer_load_dwordx2 v[12:13], v0, s[36:39], s3 offen sc1
  s_xor_b32 s74, s59, 0
  s_mul_i32 s76, s74, 196608
  s_add_u32 m0, s71, 98304
  s_nop 0
  buffer_load_dwordx4 v32, s[40:43], s76 offen lds
  v_cmp_le_i32 vcc, 20, v47
  s_nop 1
  v_cndmask_b32_e64 v108, v38, 0, vcc
  s_add_u32 m0, s71, 99328
  s_nop 0
  buffer_load_dwordx4 v33, s[40:43], s76 offen lds
  v_cndmask_b32_e64 v124, 0, v38, vcc
  v_cmp_le_i32 vcc, 21, v47
  s_xor_b32 s74, s59, 1
  s_mul_i32 s76, s74, 196608
  s_add_u32 m0, s71, 106496
  s_nop 0
  buffer_load_dwordx4 v32, s[40:43], s76 offen lds
  v_cndmask_b32_e64 v109, v38, 0, vcc
  v_cndmask_b32_e64 v125, 0, v38, vcc
  s_add_u32 m0, s71, 107520
  s_nop 0
  buffer_load_dwordx4 v33, s[40:43], s76 offen lds
  v_cmp_le_i32 vcc, 22, v47
  s_nop 1
  v_cndmask_b32_e64 v110, v38, 0, vcc
  s_xor_b32 s74, s59, 2
  s_mul_i32 s76, s74, 196608
  s_add_u32 m0, s71, 114688
  s_nop 0
  buffer_load_dwordx4 v32, s[40:43], s76 offen lds
  v_cndmask_b32_e64 v126, 0, v38, vcc
  v_cmp_le_i32 vcc, 23, v47
  s_add_u32 m0, s71, 115712
  s_nop 0
  buffer_load_dwordx4 v33, s[40:43], s76 offen lds
  v_cndmask_b32_e64 v111, v38, 0, vcc
  v_cndmask_b32_e64 v127, 0, v38, vcc
  s_xor_b32 s74, s59, 3
  s_mul_i32 s76, s74, 196608
  s_add_u32 m0, s71, 122880
  s_nop 0
  buffer_load_dwordx4 v32, s[40:43], s76 offen lds
  s_add_u32 m0, s71, 123904
  s_nop 0
  buffer_load_dwordx4 v33, s[40:43], s76 offen lds
  s_waitcnt lgkmcnt(0)
  s_waitcnt vmcnt(9)
  s_barrier
  ds_read_b128 v[240:243], v28 offset:0
  ds_read_b128 v[244:247], v29 offset:0
  ds_read_b128 v[248:251], v30 offset:0
  ds_read_b128 v[252:255], v31 offset:0
  s_xor_b32 s74, s59, 4
  s_mul_i32 s76, s74, 196608
  s_add_u32 m0, s71, 131072
  s_nop 0
  buffer_load_dwordx4 v32, s[40:43], s76 offen lds
  s_add_u32 m0, s71, 132096
  s_nop 0
  buffer_load_dwordx4 v33, s[40:43], s76 offen lds
  s_xor_b32 s74, s59, 5
  s_mul_i32 s76, s74, 196608
  s_add_u32 m0, s71, 139264
  s_nop 0
  buffer_load_dwordx4 v32, s[40:43], s76 offen lds
  s_add_u32 m0, s71, 140288
  s_nop 0
  buffer_load_dwordx4 v33, s[40:43], s76 offen lds
  s_xor_b32 s74, s59, 6
  s_mul_i32 s76, s74, 196608
  s_add_u32 m0, s71, 147456
  s_nop 0
  buffer_load_dwordx4 v32, s[40:43], s76 offen lds
  s_add_u32 m0, s71, 148480
  s_nop 0
  buffer_load_dwordx4 v33, s[40:43], s76 offen lds
  s_xor_b32 s74, s59, 7
  s_mul_i32 s76, s74, 196608
  s_add_u32 m0, s71, 155648
  s_nop 0
  buffer_load_dwordx4 v32, s[40:43], s76 offen lds
  s_add_u32 m0, s71, 156672
  s_nop 0
  buffer_load_dwordx4 v33, s[40:43], s76 offen lds
  s_waitcnt lgkmcnt(0)
  s_waitcnt vmcnt(8)
  v_cmp_ne_u32 vcc, s56, v13
  s_nop 4
  s_cbranch_vccnz L_xw1
L_xw1_ok:
  v_cmp_ne_u32 vcc, s63, v12
  s_nop 3
  s_cmp_eq_u64 vcc, 0
  s_cselect_b32 s62, 1, 0
  s_barrier
  ds_read_b64_tr_b16 v[16:17], v35 offset:0
  ds_read_b64_tr_b16 v[18:19], v35 offset:512
  ds_read_b64_tr_b16 v[20:21], v35 offset:2048
  ds_read_b64_tr_b16 v[22:23], v35 offset:2560
  ds_read_b64_tr_b16 v[24:25], v35 offset:4096
  ds_read_b64_tr_b16 v[26:27], v35 offset:4608
  ds_read_b64_tr_b16 v[28:29], v35 offset:6144
  ds_read_b64_tr_b16 v[30:31], v35 offset:6656
  s_waitcnt lgkmcnt(4)
  v_mfma_f32_32x32x16_bf16 v[64:79], v[16:19], v[128:131], 0
  ds_read_b64_tr_b16 v[36:37], v35 offset:8192
  ds_read_b64_tr_b16 v[38:39], v35 offset:8704
  v_mfma_f32_32x32x16_bf16 v[64:79], v[20:23], v[132:135], v[64:79]
  ds_read_b64_tr_b16 v[40:41], v35 offset:10240
  ds_read_b64_tr_b16 v[42:43], v35 offset:10752
  s_waitcnt lgkmcnt(4)
  v_mfma_f32_32x32x16_bf16 v[64:79], v[24:27], v[136:139], v[64:79]
  ds_read_b64_tr_b16 v[16:17], v35 offset:12288
  ds_read_b64_tr_b16 v[18:19], v35 offset:12800
  v_mfma_f32_32x32x16_bf16 v[64:79], v[28:31], v[140:143], v[64:79]
  ds_read_b64_tr_b16 v[20:21], v35 offset:14336
  ds_read_b64_tr_b16 v[22:23], v35 offset:14848
  s_waitcnt lgkmcnt(4)
  v_mfma_f32_32x32x16_bf16 v[64:79], v[36:39], v[144:147], v[64:79]
  ds_read_b64_tr_b16 v[24:25], v35 offset:16384
  ds_read_b64_tr_b16 v[26:27], v35 offset:16896
  v_mfma_f32_32x32x16_bf16 v[64:79], v[40:43], v[148:151], v[64:79]
  ds_read_b64_tr_b16 v[28:29], v35 offset:18432
  ds_read_b64_tr_b16 v[30:31], v35 offset:18944
  s_waitcnt lgkmcnt(4)
  v_mfma_f32_32x32x16_bf16 v[64:79], v[16:19], v[152:155], v[64:79]
  ds_read_b64_tr_b16 v[36:37], v35 offset:20480
  ds_read_b64_tr_b16 v[38:39], v35 offset:20992
  v_mfma_f32_32x32x16_bf16 v[64:79], v[20:23], v[156:159], v[64:79]
  ds_read_b64_tr_b16 v[40:41], v35 offset:22528
  ds_read_b64_tr_b16 v[42:43], v35 offset:23040
  s_waitcnt lgkmcnt(4)
  v_mfma_f32_32x32x16_bf16 v[64:79], v[24:27], v[160:163], v[64:79]
  ds_read_b64_tr_b16 v[16:17], v35 offset:24576
  ds_read_b64_tr_b16 v[18:19], v35 offset:25088
  v_mfma_f32_32x32x16_bf16 v[64:79], v[28:31], v[164:167], v[64:79]
  ds_read_b64_tr_b16 v[20:21], v35 offset:26624
  ds_read_b64_tr_b16 v[22:23], v35 offset:27136
  s_waitcnt lgkmcnt(4)
  v_mfma_f32_32x32x16_bf16 v[64:79], v[36:39], v[168:171], v[64:79]
  ds_read_b64_tr_b16 v[24:25], v35 offset:28672
  ds_read_b64_tr_b16 v[26:27], v35 offset:29184
  v_mfma_f32_32x32x16_bf16 v[64:79], v[40:43], v[172:175], v[64:79]
  ds_read_b64_tr_b16 v[28:29], v35 offset:30720
  ds_read_b64_tr_b16 v[30:31], v35 offset:31232
  s_waitcnt lgkmcnt(4)
  v_mfma_f32_32x32x16_bf16 v[64:79], v[16:19], v[176:179], v[64:79]
  s_waitcnt vmcnt(0)
  s_barrier
  ds_read_b64_tr_b16 v[36:37], v35 offset:32768
  ds_read_b64_tr_b16 v[38:39], v35 offset:33280
  v_mfma_f32_32x32x16_bf16 v[64:79], v[20:23], v[180:183], v[64:79]
  ds_read_b64_tr_b16 v[40:41], v35 offset:34816
  ds_read_b64_tr_b16 v[42:43], v35 offset:35328
  s_waitcnt lgkmcnt(4)
  v_mfma_f32_32x32x16_bf16 v[64:79], v[24:27], v[184:187], v[64:79]
  ds_read_b64_tr_b16 v[16:17], v35 offset:36864
  ds_read_b64_tr_b16 v[18:19], v35 offset:37376
  v_mfma_f32_32x32x16_bf16 v[64:79], v[28:31], v[188:191], v[64:79]
  ds_read_b64_tr_b16 v[20:21], v35 offset:38912
  ds_read_b64_tr_b16 v[22:23], v35 offset:39424
  s_waitcnt lgkmcnt(4)
  v_mfma_f32_32x32x16_bf16 v[64:79], v[36:39], v[192:195], v[64:79]
  ds_read_b64_tr_b16 v[24:25], v35 offset:40960
  ds_read_b64_tr_b16 v[26:27], v35 offset:41472
  v_mfma_f32_32x32x16_bf16 v[64:79], v[40:43], v[196:199], v[64:79]
  ds_read_b64_tr_b16 v[28:29], v35 offset:43008
  ds_read_b64_tr_b16 v[30:31], v35 offset:43520
  s_waitcnt lgkmcnt(4)
  v_mfma_f32_32x32x16_bf16 v[64:79], v[16:19], v[200:203], v[64:79]
  ds_read_b64_tr_b16 v[36:37], v35 offset:45056
  ds_read_b64_tr_b16 v[38:39], v35 offset:45568
  v_mfma_f32_32x32x16_bf16 v[64:79], v[20:23], v[204:207], v[64:79]
  ds_read_b64_tr_b16 v[40:41], v35 offset:47104
  ds_read_b64_tr_b16 v[42:43], v35 offset:47616
  s_waitcnt lgkmcnt(4)
  v_mfma_f32_32x32x16_bf16 v[64:79], v[24:27], v[208:211], v[64:79]
  ds_read_b64_tr_b16 v[16:17], v35 offset:49152
  ds_read_b64_tr_b16 v[18:19], v35 offset:49664
  v_and_b32 v46, 27, v1
  v_cmp_eq_u32 vcc, 16, v46
  v_mov_b32 v47, 0x3f803f80
  v_mfma_f32_32x32x16_bf16 v[64:79], v[28:31], v[212:215], v[64:79]
  ds_read_b64_tr_b16 v[20:21], v35 offset:51200
  ds_read_b64_tr_b16 v[22:23], v35 offset:51712
  s_waitcnt lgkmcnt(4)
  v_mfma_f32_32x32x16_bf16 v[64:79], v[36:39], v[216:219], v[64:79]
  ds_read_b64_tr_b16 v[24:25], v35 offset:53248
  ds_read_b64_tr_b16 v[26:27], v35 offset:53760
  v_cndmask_b32_e64 v46, 0, v47, vcc
  v_cndmask_b32_e64 v47, 0, v47, vcc
  v_mfma_f32_32x32x16_bf16 v[64:79], v[40:43], v[220:223], v[64:79]
  ds_read_b64_tr_b16 v[28:29], v35 offset:55296
  ds_read_b64_tr_b16 v[30:31], v35 offset:55808
  s_waitcnt lgkmcnt(4)
  v_mfma_f32_32x32x16_bf16 v[64:79], v[16:19], v[224:227], v[64:79]
  ds_read_b64_tr_b16 v[36:37], v35 offset:57344
  ds_read_b64_tr_b16 v[38:39], v35 offset:57856
  v_mfma_f32_32x32x16_bf16 v[64:79], v[20:23], v[228:231], v[64:79]
  ds_read_b64_tr_b16 v[40:41], v35 offset:59392
  ds_read_b64_tr_b16 v[42:43], v35 offset:59904
  s_waitcnt lgkmcnt(4)
  v_mfma_f32_32x32x16_bf16 v[64:79], v[24:27], v[232:235], v[64:79]
  ds_read_b64_tr_b16 v[16:17], v35 offset:61440
  ds_read_b64_tr_b16 v[18:19], v35 offset:61952
  v_mfma_f32_32x32x16_bf16 v[64:79], v[28:31], v[236:239], v[64:79]
  ds_read_b64_tr_b16 v[20:21], v35 offset:63488
  ds_read_b64_tr_b16 v[22:23], v35 offset:64000
  s_waitcnt lgkmcnt(4)
  v_mfma_f32_32x32x16_bf16 v[64:79], v[36:39], v[240:243], v[64:79]
  ds_read_b64_tr_b16 v[24:25], v34 offset:0
  ds_read_b64_tr_b16 v[26:27], v34 offset:512
  v_mfma_f32_32x32x16_bf16 v[64:79], v[40:43], v[244:247], v[64:79]
  ds_read_b64_tr_b16 v[28:29], v34 offset:2048
  ds_read_b64_tr_b16 v[30:31], v34 offset:2560
  s_waitcnt lgkmcnt(4)
  v_mfma_f32_32x32x16_bf16 v[64:79], v[16:19], v[248:251], v[64:79]
  ds_read_b64_tr_b16 v[36:37], v34 offset:4096
  ds_read_b64_tr_b16 v[38:39], v34 offset:4608
  v_mfma_f32_32x32x16_bf16 v[64:79], v[20:23], v[252:255], v[64:79]
  ds_read_b64_tr_b16 v[40:41], v34 offset:6144
  ds_read_b64_tr_b16 v[42:43], v34 offset:6656
  s_waitcnt lgkmcnt(4)
  v_mfma_f32_32x32x16_bf16 v[80:95], v[24:27], v[128:131], 0
  ds_read_b64_tr_b16 v[16:17], v34 offset:8192
  ds_read_b64_tr_b16 v[18:19], v34 offset:8704
  v_mfma_f32_32x32x16_bf16 v[80:95], v[28:31], v[132:135], v[80:95]
  ds_read_b64_tr_b16 v[20:21], v34 offset:10240
  ds_read_b64_tr_b16 v[22:23], v34 offset:10752
  s_waitcnt lgkmcnt(4)
  v_mfma_f32_32x32x16_bf16 v[80:95], v[36:39], v[136:139], v[80:95]
  ds_read_b64_tr_b16 v[24:25], v34 offset:12288
  ds_read_b64_tr_b16 v[26:27], v34 offset:12800
  v_mfma_f32_32x32x16_bf16 v[80:95], v[40:43], v[140:143], v[80:95]
  ds_read_b64_tr_b16 v[28:29], v34 offset:14336
  ds_read_b64_tr_b16 v[30:31], v34 offset:14848
  v_mul_f32 v64, s10, v64
  v_mul_f32 v65, s10, v65
  v_mul_f32 v66, s10, v66
  s_waitcnt lgkmcnt(4)
  v_mfma_f32_32x32x16_bf16 v[80:95], v[16:19], v[144:147], v[80:95]
  ds_read_b64_tr_b16 v[36:37], v34 offset:16384
  ds_read_b64_tr_b16 v[38:39], v34 offset:16896
  v_mul_f32 v67, s10, v67
  v_mul_f32 v68, s10, v68
  v_mul_f32 v69, s10, v69
  v_mfma_f32_32x32x16_bf16 v[80:95], v[20:23], v[148:151], v[80:95]
  ds_read_b64_tr_b16 v[40:41], v34 offset:18432
  ds_read_b64_tr_b16 v[42:43], v34 offset:18944
  v_mul_f32 v70, s10, v70
  v_mul_f32 v71, s10, v71
  v_mul_f32 v72, s10, v72
  s_waitcnt lgkmcnt(4)
  v_mfma_f32_32x32x16_bf16 v[80:95], v[24:27], v[152:155], v[80:95]
  ds_read_b64_tr_b16 v[16:17], v34 offset:20480
  ds_read_b64_tr_b16 v[18:19], v34 offset:20992
  v_mul_f32 v73, s10, v73
  v_mul_f32 v74, s10, v74
  v_mul_f32 v75, s10, v75
  v_mfma_f32_32x32x16_bf16 v[80:95], v[28:31], v[156:159], v[80:95]
  ds_read_b64_tr_b16 v[20:21], v34 offset:22528
  ds_read_b64_tr_b16 v[22:23], v34 offset:23040
  v_mul_f32 v76, s10, v76
  v_mul_f32 v77, s10, v77
  v_mul_f32 v78, s10, v78
  s_waitcnt lgkmcnt(4)
  v_mfma_f32_32x32x16_bf16 v[80:95], v[36:39], v[160:163], v[80:95]
  ds_read_b64_tr_b16 v[24:25], v34 offset:24576
  ds_read_b64_tr_b16 v[26:27], v34 offset:25088
  v_mul_f32 v79, s10, v79
  v_cvt_pk_bf16_f32 v64, v64, v65
  v_cvt_pk_bf16_f32 v65, v66, v67
  v_mfma_f32_32x32x16_bf16 v[80:95], v[40:43], v[164:167], v[80:95]
  ds_read_b64_tr_b16 v[28:29], v34 offset:26624
  ds_read_b64_tr_b16 v[30:31], v34 offset:27136
  v_cvt_pk_bf16_f32 v66, v68, v69
  v_cvt_pk_bf16_f32 v67, v70, v71
  v_cvt_pk_bf16_f32 v68, v72, v73
  s_waitcnt lgkmcnt(4)
  v_mfma_f32_32x32x16_bf16 v[80:95], v[16:19], v[168:171], v[80:95]
  ds_read_b64_tr_b16 v[36:37], v34 offset:28672
  ds_read_b64_tr_b16 v[38:39], v34 offset:29184
  v_cvt_pk_bf16_f32 v69, v74, v75
  v_cvt_pk_bf16_f32 v70, v76, v77
  v_cvt_pk_bf16_f32 v71, v78, v79
  v_mfma_f32_32x32x16_bf16 v[80:95], v[20:23], v[172:175], v[80:95]
  ds_read_b64_tr_b16 v[40:41], v34 offset:30720
  ds_read_b64_tr_b16 v[42:43], v34 offset:31232
  s_cmp_eq_u32 s54, 0
  s_cbranch_scc1 L_noq1
  s_cmp_eq_u32 s62, 0
  s_cbranch_scc1 L_bo2
  buffer_store_dwordx4 v[64:67], v2, s[36:39], s7 offen offset:0
  buffer_store_dwordx4 v[68:71], v2, s[36:39], s7 offen offset:1024
L_bo2_r:
L_noq1:
  s_waitcnt lgkmcnt(4)
  v_mfma_f32_32x32x16_bf16 v[80:95], v[24:27], v[176:179], v[80:95]
  ds_read_b64_tr_b16 v[16:17], v34 offset:32768
  ds_read_b64_tr_b16 v[18:19], v34 offset:33280
  v_mfma_f32_32x32x16_bf16 v[80:95], v[28:31], v[180:183], v[80:95]
  ds_read_b64_tr_b16 v[20:21], v34 offset:34816
  ds_read_b64_tr_b16 v[22:23], v34 offset:35328
  s_waitcnt lgkmcnt(4)
  v_mfma_f32_32x32x16_bf16 v[80:95], v[36:39], v[184:187], v[80:95]
  ds_read_b64_tr_b16 v[24:25], v34 offset:36864
  ds_read_b64_tr_b16 v[26:27], v34 offset:37376
  v_mfma_f32_32x32x16_bf16 v[80:95], v[40:43], v[188:191], v[80:95]
  ds_read_b64_tr_b16 v[28:29], v34 offset:38912
  ds_read_b64_tr_b16 v[30:31], v34 offset:39424
  s_waitcnt lgkmcnt(4)
  v_mfma_f32_32x32x16_bf16 v[80:95], v[16:19], v[192:195], v[80:95]
  ds_read_b64_tr_b16 v[36:37], v34 offset:40960
  ds_read_b64_tr_b16 v[38:39], v34 offset:41472
  v_mov_b64 v[128:129], v[46:47]
  v_mfma_f32_32x32x16_bf16 v[80:95], v[20:23], v[196:199], v[80:95]
  ds_read_b64_tr_b16 v[40:41], v34 offset:43008
  ds_read_b64_tr_b16 v[42:43], v34 offset:43520
  v_mov_b64 v[130:131], v[46:47]
  s_waitcnt lgkmcnt(4)
  v_mfma_f32_32x32x16_bf16 v[80:95], v[24:27], v[200:203], v[80:95]
  ds_read_b64_tr_b16 v[16:17], v34 offset:45056
  ds_read_b64_tr_b16 v[18:19], v34 offset:45568
  v_mov_b64 v[132:133], v[46:47]
  v_mfma_f32_32x32x16_bf16 v[80:95], v[28:31], v[204:207], v[80:95]
  ds_read_b64_tr_b16 v[20:21], v34 offset:47104
  ds_read_b64_tr_b16 v[22:23], v34 offset:47616
  v_mov_b64 v[134:135], v[46:47]
  s_waitcnt lgkmcnt(4)
  v_mfma_f32_32x32x16_bf16 v[80:95], v[36:39], v[208:211], v[80:95]
  ds_read_b64_tr_b16 v[24:25], v34 offset:49152
  ds_read_b64_tr_b16 v[26:27], v34 offset:49664
  v_mov_b64 v[136:137], v[46:47]
  v_mfma_f32_32x32x16_bf16 v[80:95], v[40:43], v[212:215], v[80:95]
  ds_read_b64_tr_b16 v[28:29], v34 offset:51200
  ds_read_b64_tr_b16 v[30:31], v34 offset:51712
  v_mov_b64 v[138:139], v[46:47]
  s_waitcnt lgkmcnt(4)
  v_mfma_f32_32x32x16_bf16 v[80:95], v[16:19], v[216:219], v[80:95]
  ds_read_b64_tr_b16 v[36:37], v34 offset:53248
  ds_read_b64_tr_b16 v[38:39], v34 offset:53760
  v_mov_b64 v[140:141], v[46:47]
  v_mfma_f32_32x32x16_bf16 v[80:95], v[20:23], v[220:223], v[80:95]
  ds_read_b64_tr_b16 v[40:41], v34 offset:55296
  ds_read_b64_tr_b16 v[42:43], v34 offset:55808
  v_mov_b64 v[142:143], v[46:47]
  s_waitcnt lgkmcnt(4)
  v_mfma_f32_32x32x16_bf16 v[80:95], v[24:27], v[224:227], v[80:95]
  ds_read_b64_tr_b16 v[16:17], v34 offset:57344
  ds_read_b64_tr_b16 v[18:19], v34 offset:57856
  v_mov_b64 v[144:145], v[46:47]
  s_cmp_eq_u32 s54, 0
  s_cbranch_scc1 L_noq2
  s_waitcnt vmcnt(0)
  s_mov_b64 exec, 1
  s_cmp_eq_u32 s62, 0
  s_cbranch_scc1 L_bo3
  buffer_store_dword v14, v15, s[36:39], s8 offen
L_bo3_r:
  s_mov_b64 exec, -1
L_noq2:
  v_mfma_f32_32x32x16_bf16 v[80:95], v[28:31], v[228:231], v[80:95]
  ds_read_b64_tr_b16 v[20:21], v34 offset:59392
  ds_read_b64_tr_b16 v[22:23], v34 offset:59904
  v_mov_b64 v[146:147], v[46:47]
  s_waitcnt lgkmcnt(4)
  v_mfma_f32_32x32x16_bf16 v[80:95], v[36:39], v[232:235], v[80:95]
  ds_read_b64_tr_b16 v[24:25], v34 offset:61440
  ds_read_b64_tr_b16 v[26:27], v34 offset:61952
  v_mov_b64 v[148:149], v[46:47]
  v_mfma_f32_32x32x16_bf16 v[80:95], v[40:43], v[236:239], v[80:95]
  ds_read_b64_tr_b16 v[28:29], v34 offset:63488
  ds_read_b64_tr_b16 v[30:31], v34 offset:64000
  v_mov_b64 v[150:151], v[46:47]
  s_waitcnt lgkmcnt(4)
  v_mfma_f32_32x32x16_bf16 v[80:95], v[16:19], v[240:243], v[80:95]
  v_mov_b64 v[152:153], v[46:47]
  v_mfma_f32_32x32x16_bf16 v[80:95], v[20:23], v[244:247], v[80:95]
  v_mov_b64 v[154:155], v[46:47]
  s_waitcnt lgkmcnt(0)
  v_mfma_f32_32x32x16_bf16 v[80:95], v[24:27], v[248:251], v[80:95]
  v_mov_b64 v[156:157], v[46:47]
  v_mfma_f32_32x32x16_bf16 v[80:95], v[28:31], v[252:255], v[80:95]
  v_mov_b64 v[158:159], v[46:47]
  s_cmp_eq_u32 s54, 0
  s_cbranch_scc1 L_qA
  s_nop 8
  v_mul_f32 v80, s10, v80
  v_mul_f32 v81, s10, v81
  v_mul_f32 v82, s10, v82
  v_mul_f32 v83, s10, v83
  v_mul_f32 v84, s10, v84
  v_mul_f32 v85, s10, v85
  v_mul_f32 v86, s10, v86
  v_mul_f32 v87, s10, v87
  v_mul_f32 v88, s10, v88
  v_mul_f32 v89, s10, v89
  v_mul_f32 v90, s10, v90
  v_mul_f32 v91, s10, v91
  v_mul_f32 v92, s10, v92
  v_mul_f32 v93, s10, v93
  v_mul_f32 v94, s10, v94
  v_mul_f32 v95, s10, v95
  v_cvt_pk_bf16_f32 v72, v80, v81
  v_cvt_pk_bf16_f32 v73, v82, v83
  v_cvt_pk_bf16_f32 v74, v84, v85
  v_cvt_pk_bf16_f32 v75, v86, v87
  v_cvt_pk_bf16_f32 v76, v88, v89
  v_cvt_pk_bf16_f32 v77, v90, v91
  v_cvt_pk_bf16_f32 v78, v92, v93
  v_cvt_pk_bf16_f32 v79, v94, v95
L_qdone:
  s_setprio 1
  s_barrier
L_attgo:
  ds_read_b128 v[88:91], v44 offset:16384
  ds_read_b128 v[92:95], v44 offset:40960
  ds_read_b128 v[240:243], v44 offset:14336
  s_mov_b64 exec, s[60:61]
  ds_read_b128 v[144:147], v45 offset:16384
  ds_read_b128 v[148:151], v45 offset:16896
  ds_read_b128 v[152:155], v45 offset:40960
  ds_read_b128 v[156:159], v45 offset:41472
  s_mov_b64 exec, -1
  s_waitcnt lgkmcnt(6)
  v_mfma_f32_32x32x16_bf16 v[160:175], v[88:91], v[72:75], v[96:111]
  s_nop 11
  v_exp_f32 v160, v160
  v_exp_f32 v161, v161
  v_exp_f32 v162, v162
  v_exp_f32 v163, v163
  v_exp_f32 v164, v164
  s_waitcnt lgkmcnt(0)
  v_mfma_f32_32x32x16_bf16 v[176:191], v[92:95], v[76:79], v[96:111]
  s_mov_b64 exec, s[60:61]
  ds_read_b128 v[128:131], v45 offset:14336
  ds_read_b128 v[132:135], v45 offset:14848
  ds_read_b128 v[136:139], v45 offset:38912
  ds_read_b128 v[140:143], v45 offset:39424
  s_mov_b64 exec, -1
  ds_read_b128 v[244:247], v44 offset:38912
  ds_read_b128 v[88:91], v44 offset:12288
  v_exp_f32 v165, v165
  v_exp_f32 v166, v166
  v_exp_f32 v167, v167
  v_cvt_pk_bf16_f32 v80, v160, v161
  v_cvt_pk_bf16_f32 v81, v162, v163
  v_cvt_pk_bf16_f32 v82, v164, v165
  v_cvt_pk_bf16_f32 v83, v166, v167
  v_exp_f32 v168, v168
  v_exp_f32 v169, v169
  v_mfma_f32_32x32x16_bf16 v[192:207], v[144:147], v[80:83], 0
  v_exp_f32 v170, v170
  v_exp_f32 v171, v171
  v_exp_f32 v172, v172
  v_exp_f32 v173, v173
  v_exp_f32 v174, v174
  v_exp_f32 v175, v175
  v_cvt_pk_bf16_f32 v84, v168, v169
  v_cvt_pk_bf16_f32 v85, v170, v171
  v_cvt_pk_bf16_f32 v86, v172, v173
  v_cvt_pk_bf16_f32 v87, v174, v175
  v_exp_f32 v176, v176
  v_exp_f32 v177, v177
  v_mfma_f32_32x32x16_bf16 v[192:207], v[148:151], v[84:87], v[192:207]
  v_exp_f32 v178, v178
  v_exp_f32 v179, v179
  v_exp_f32 v180, v180
  v_mfma_f32_32x32x16_bf16 v[160:175], v[240:243], v[72:75], 0
  v_exp_f32 v181, v181
  v_exp_f32 v182, v182
  v_exp_f32 v183, v183
  v_cvt_pk_bf16_f32 v80, v176, v177
  v_cvt_pk_bf16_f32 v81, v178, v179
  v_cvt_pk_bf16_f32 v82, v180, v181
  v_cvt_pk_bf16_f32 v83, v182, v183
  v_exp_f32 v184, v184
  v_exp_f32 v185, v185
  v_mfma_f32_32x32x16_bf16 v[208:223], v[152:155], v[80:83], 0
  v_exp_f32 v186, v186
  v_exp_f32 v187, v187
  v_exp_f32 v188, v188
  v_exp_f32 v189, v189
  v_exp_f32 v190, v190
  v_exp_f32 v191, v191
  s_cmp_eq_u32 s6, 0
  v_cvt_pk_bf16_f32 v84, v184, v185
  v_cvt_pk_bf16_f32 v85, v186, v187
  v_cvt_pk_bf16_f32 v86, v188, v189
  v_cvt_pk_bf16_f32 v87, v190, v191
  s_cbranch_scc1 L_ax0s
  v_exp_f32 v160, v160
  v_exp_f32 v161, v161
  v_mfma_f32_32x32x16_bf16 v[208:223], v[156:159], v[84:87], v[208:223]
  v_exp_f32 v162, v162
  v_exp_f32 v163, v163
  v_exp_f32 v164, v164
  s_waitcnt lgkmcnt(0)
  v_mfma_f32_32x32x16_bf16 v[176:191], v[244:247], v[76:79], 0
  s_mov_b64 exec, s[60:61]
  ds_read_b128 v[144:147], v45 offset:12288
  ds_read_b128 v[148:151], v45 offset:12800
  ds_read_b128 v[152:155], v45 offset:36864
  ds_read_b128 v[156:159], v45 offset:37376
  s_mov_b64 exec, -1
  ds_read_b128 v[92:95], v44 offset:36864
  ds_read_b128 v[240:243], v44 offset:10240
  v_exp_f32 v165, v165
  v_exp_f32 v166, v166
  v_exp_f32 v167, v167
  v_cvt_pk_bf16_f32 v80, v160, v161
  v_cvt_pk_bf16_f32 v81, v162, v163
  v_cvt_pk_bf16_f32 v82, v164, v165
  v_cvt_pk_bf16_f32 v83, v166, v167
  v_exp_f32 v168, v168
  v_exp_f32 v169, v169
  v_mfma_f32_32x32x16_bf16 v[192:207], v[128:131], v[80:83], v[192:207]
  v_exp_f32 v170, v170
  v_exp_f32 v171, v171
  v_exp_f32 v172, v172
  v_exp_f32 v173, v173
  v_exp_f32 v174, v174
  v_exp_f32 v175, v175
  v_cvt_pk_bf16_f32 v84, v168, v169
  v_cvt_pk_bf16_f32 v85, v170, v171
  v_cvt_pk_bf16_f32 v86, v172, v173
  v_cvt_pk_bf16_f32 v87, v174, v175
  v_exp_f32 v176, v176
  v_exp_f32 v177, v177
  v_mfma_f32_32x32x16_bf16 v[192:207], v[132:135], v[84:87], v[192:207]
  v_exp_f32 v178, v178
  v_exp_f32 v179, v179
  v_exp_f32 v180, v180
  v_mfma_f32_32x32x16_bf16 v[160:175], v[88:91], v[72:75], 0
  v_exp_f32 v181, v181
  v_exp_f32 v182, v182
  v_exp_f32 v183, v183
  v_cvt_pk_bf16_f32 v80, v176, v177
  v_cvt_pk_bf16_f32 v81, v178, v179
  v_cvt_pk_bf16_f32 v82, v180, v181
  v_cvt_pk_bf16_f32 v83, v182, v183
  v_exp_f32 v184, v184
  v_exp_f32 v185, v185
  v_mfma_f32_32x32x16_bf16 v[208:223], v[136:139], v[80:83], v[208:223]
  v_exp_f32 v186, v186
  v_exp_f32 v187, v187
  v_exp_f32 v188, v188
  v_exp_f32 v189, v189
  v_exp_f32 v190, v190
  v_exp_f32 v191, v191
  s_cmp_eq_u32 s6, 1
  v_cvt_pk_bf16_f32 v84, v184, v185
  v_cvt_pk_bf16_f32 v85, v186, v187
  v_cvt_pk_bf16_f32 v86, v188, v189
  v_cvt_pk_bf16_f32 v87, v190, v191
  s_cbranch_scc1 L_ax1s
  v_exp_f32 v160, v160
  v_exp_f32 v161, v161
  v_mfma_f32_32x32x16_bf16 v[208:223], v[140:143], v[84:87], v[208:223]
  v_exp_f32 v162, v162
  v_exp_f32 v163, v163
  v_exp_f32 v164, v164
  s_waitcnt lgkmcnt(0)
  v_mfma_f32_32x32x16_bf16 v[176:191], v[92:95], v[76:79], 0
  s_mov_b64 exec, s[60:61]
  ds_read_b128 v[128:131], v45 offset:10240
  ds_read_b128 v[132:135], v45 offset:10752
  ds_read_b128 v[136:139], v45 offset:34816
  ds_read_b128 v[140:143], v45 offset:35328
  s_mov_b64 exec, -1
  ds_read_b128 v[244:247], v44 offset:34816
  ds_read_b128 v[88:91], v44 offset:8192
  v_exp_f32 v165, v165
  v_exp_f32 v166, v166
  v_exp_f32 v167, v167
  v_cvt_pk_bf16_f32 v80, v160, v161
  v_cvt_pk_bf16_f32 v81, v162, v163
  v_cvt_pk_bf16_f32 v82, v164, v165
  v_cvt_pk_bf16_f32 v83, v166, v167
  v_exp_f32 v168, v168
  v_exp_f32 v169, v169
  v_mfma_f32_32x32x16_bf16 v[192:207], v[144:147], v[80:83], v[192:207]
  v_exp_f32 v170, v170
  v_exp_f32 v171, v171
  v_exp_f32 v172, v172
  v_exp_f32 v173, v173
  v_exp_f32 v174, v174
  v_exp_f32 v175, v175
  v_cvt_pk_bf16_f32 v84, v168, v169
  v_cvt_pk_bf16_f32 v85, v170, v171
  v_cvt_pk_bf16_f32 v86, v172, v173
  v_cvt_pk_bf16_f32 v87, v174, v175
  v_exp_f32 v176, v176
  v_exp_f32 v177, v177
  v_mfma_f32_32x32x16_bf16 v[192:207], v[148:151], v[84:87], v[192:207]
  v_exp_f32 v178, v178
  v_exp_f32 v179, v179
  v_exp_f32 v180, v180
  v_mfma_f32_32x32x16_bf16 v[160:175], v[240:243], v[72:75], 0
  v_exp_f32 v181, v181
  v_exp_f32 v182, v182
  v_exp_f32 v183, v183
  v_cvt_pk_bf16_f32 v80, v176, v177
  v_cvt_pk_bf16_f32 v81, v178, v179
  v_cvt_pk_bf16_f32 v82, v180, v181
  v_cvt_pk_bf16_f32 v83, v182, v183
  v_exp_f32 v184, v184
  v_exp_f32 v185, v185
  v_mfma_f32_32x32x16_bf16 v[208:223], v[152:155], v[80:83], v[208:223]
  v_exp_f32 v186, v186
  v_exp_f32 v187, v187
  v_exp_f32 v188, v188
  v_exp_f32 v189, v189
  v_exp_f32 v190, v190
  v_exp_f32 v191, v191
  s_cmp_eq_u32 s6, 2
  v_cvt_pk_bf16_f32 v84, v184, v185
  v_cvt_pk_bf16_f32 v85, v186, v187
  v_cvt_pk_bf16_f32 v86, v188, v189
  v_cvt_pk_bf16_f32 v87, v190, v191
  s_cbranch_scc1 L_ax0s
  v_exp_f32 v160, v160
  v_exp_f32 v161, v161
  v_mfma_f32_32x32x16_bf16 v[208:223], v[156:159], v[84:87], v[208:223]
  v_exp_f32 v162, v162
  v_exp_f32 v163, v163
  v_exp_f32 v164, v164
  s_waitcnt lgkmcnt(0)
  v_mfma_f32_32x32x16_bf16 v[176:191], v[244:247], v[76:79], 0
  s_mov_b64 exec, s[60:61]
  ds_read_b128 v[144:147], v45 offset:8192
  ds_read_b128 v[148:151], v45 offset:8704
  ds_read_b128 v[152:155], v45 offset:32768
  ds_read_b128 v[156:159], v45 offset:33280
  s_mov_b64 exec, -1
  ds_read_b128 v[92:95], v44 offset:32768
  ds_read_b128 v[240:243], v44 offset:6144
  v_exp_f32 v165, v165
  v_exp_f32 v166, v166
  v_exp_f32 v167, v167
  v_cvt_pk_bf16_f32 v80, v160, v161
  v_cvt_pk_bf16_f32 v81, v162, v163
  v_cvt_pk_bf16_f32 v82, v164, v165
  v_cvt_pk_bf16_f32 v83, v166, v167
  v_exp_f32 v168, v168
  v_exp_f32 v169, v169
  v_mfma_f32_32x32x16_bf16 v[192:207], v[128:131], v[80:83], v[192:207]
  v_exp_f32 v170, v170
  v_exp_f32 v171, v171
  v_exp_f32 v172, v172
  v_exp_f32 v173, v173
  v_exp_f32 v174, v174
  v_exp_f32 v175, v175
  v_cvt_pk_bf16_f32 v84, v168, v169
  v_cvt_pk_bf16_f32 v85, v170, v171
  v_cvt_pk_bf16_f32 v86, v172, v173
  v_cvt_pk_bf16_f32 v87, v174, v175
  v_exp_f32 v176, v176
  v_exp_f32 v177, v177
  v_mfma_f32_32x32x16_bf16 v[192:207], v[132:135], v[84:87], v[192:207]
  v_exp_f32 v178, v178
  v_exp_f32 v179, v179
  v_exp_f32 v180, v180
  v_mfma_f32_32x32x16_bf16 v[160:175], v[88:91], v[72:75], 0
  v_exp_f32 v181, v181
  v_exp_f32 v182, v182
  v_exp_f32 v183, v183
  v_cvt_pk_bf16_f32 v80, v176, v177
  v_cvt_pk_bf16_f32 v81, v178, v179
  v_cvt_pk_bf16_f32 v82, v180, v181
  v_cvt_pk_bf16_f32 v83, v182, v183
  v_exp_f32 v184, v184
  v_exp_f32 v185, v185
  v_mfma_f32_32x32x16_bf16 v[208:223], v[136:139], v[80:83], v[208:223]
  v_exp_f32 v186, v186
  v_exp_f32 v187, v187
  v_exp_f32 v188, v188
  v_exp_f32 v189, v189
  v_exp_f32 v190, v190
  v_exp_f32 v191, v191
  s_cmp_eq_u32 s6, 3
  v_cvt_pk_bf16_f32 v84, v184, v185
  v_cvt_pk_bf16_f32 v85, v186, v187
  v_cvt_pk_bf16_f32 v86, v188, v189
  v_cvt_pk_bf16_f32 v87, v190, v191
  s_cbranch_scc1 L_ax1s
  v_exp_f32 v160, v160
  v_exp_f32 v161, v161
  v_mfma_f32_32x32x16_bf16 v[208:223], v[140:143], v[84:87], v[208:223]
  v_exp_f32 v162, v162
  v_exp_f32 v163, v163
  v_exp_f32 v164, v164
  s_waitcnt lgkmcnt(0)
  v_mfma_f32_32x32x16_bf16 v[176:191], v[92:95], v[76:79], 0
  s_mov_b64 exec, 15
  ds_write_b32 v8, v14
  s_mov_b64 exec, -1
  s_mov_b64 exec, s[60:61]
  ds_read_b128 v[128:131], v45 offset:6144
  ds_read_b128 v[132:135], v45 offset:6656
  ds_read_b128 v[136:139], v45 offset:30720
  ds_read_b128 v[140:143], v45 offset:31232
  s_mov_b64 exec, -1
  ds_read_b128 v[244:247], v44 offset:30720
  ds_read_b128 v[88:91], v44 offset:4096
  v_exp_f32 v165, v165
  v_exp_f32 v166, v166
  v_exp_f32 v167, v167
  v_cvt_pk_bf16_f32 v80, v160, v161
  v_cvt_pk_bf16_f32 v81, v162, v163
  v_cvt_pk_bf16_f32 v82, v164, v165
  v_cvt_pk_bf16_f32 v83, v166, v167
  v_exp_f32 v168, v168
  v_exp_f32 v169, v169
  v_mfma_f32_32x32x16_bf16 v[192:207], v[144:147], v[80:83], v[192:207]
  v_exp_f32 v170, v170
  v_exp_f32 v171, v171
  v_exp_f32 v172, v172
  v_exp_f32 v173, v173
  v_exp_f32 v174, v174
  v_exp_f32 v175, v175
  v_cvt_pk_bf16_f32 v84, v168, v169
  v_cvt_pk_bf16_f32 v85, v170, v171
  v_cvt_pk_bf16_f32 v86, v172, v173
  v_cvt_pk_bf16_f32 v87, v174, v175
  v_exp_f32 v176, v176
  v_exp_f32 v177, v177
  v_mfma_f32_32x32x16_bf16 v[192:207], v[148:151], v[84:87], v[192:207]
  v_exp_f32 v178, v178
  v_exp_f32 v179, v179
  v_exp_f32 v180, v180
  v_mfma_f32_32x32x16_bf16 v[160:175], v[240:243], v[72:75], 0
  v_exp_f32 v181, v181
  v_exp_f32 v182, v182
  v_exp_f32 v183, v183
  v_cvt_pk_bf16_f32 v80, v176, v177
  v_cvt_pk_bf16_f32 v81, v178, v179
  v_cvt_pk_bf16_f32 v82, v180, v181
  v_cvt_pk_bf16_f32 v83, v182, v183
  v_exp_f32 v184, v184
  v_exp_f32 v185, v185
  v_mfma_f32_32x32x16_bf16 v[208:223], v[152:155], v[80:83], v[208:223]
  v_exp_f32 v186, v186
  v_exp_f32 v187, v187
  v_exp_f32 v188, v188
  v_exp_f32 v189, v189
  v_exp_f32 v190, v190
  v_exp_f32 v191, v191
  s_cmp_eq_u32 s6, 4
  v_cvt_pk_bf16_f32 v84, v184, v185
  v_cvt_pk_bf16_f32 v85, v186, v187
  v_cvt_pk_bf16_f32 v86, v188, v189
  v_cvt_pk_bf16_f32 v87, v190, v191
  s_cbranch_scc1 L_ax0
  v_exp_f32 v160, v160
  v_exp_f32 v161, v161
  v_mfma_f32_32x32x16_bf16 v[208:223], v[156:159], v[84:87], v[208:223]
  v_exp_f32 v162, v162
  v_exp_f32 v163, v163
  v_exp_f32 v164, v164
  s_waitcnt lgkmcnt(0)
  v_mfma_f32_32x32x16_bf16 v[176:191], v[244:247], v[76:79], 0
  s_mov_b64 exec, s[60:61]
  ds_read_b128 v[144:147], v45 offset:4096
  ds_read_b128 v[148:151], v45 offset:4608
  ds_read_b128 v[152:155], v45 offset:28672
  ds_read_b128 v[156:159], v45 offset:29184
  s_mov_b64 exec, -1
  ds_read_b128 v[92:95], v44 offset:28672
  ds_read_b128 v[240:243], v44 offset:2048
  v_exp_f32 v165, v165
  v_exp_f32 v166, v166
  v_exp_f32 v167, v167
  v_cvt_pk_bf16_f32 v80, v160, v161
  v_cvt_pk_bf16_f32 v81, v162, v163
  v_cvt_pk_bf16_f32 v82, v164, v165
  v_cvt_pk_bf16_f32 v83, v166, v167
  v_exp_f32 v168, v168
  v_exp_f32 v169, v169
  v_mfma_f32_32x32x16_bf16 v[192:207], v[128:131], v[80:83], v[192:207]
  v_exp_f32 v170, v170
  v_exp_f32 v171, v171
  v_exp_f32 v172, v172
  v_exp_f32 v173, v173
  v_exp_f32 v174, v174
  v_exp_f32 v175, v175
  v_cvt_pk_bf16_f32 v84, v168, v169
  v_cvt_pk_bf16_f32 v85, v170, v171
  v_cvt_pk_bf16_f32 v86, v172, v173
  v_cvt_pk_bf16_f32 v87, v174, v175
  v_exp_f32 v176, v176
  v_exp_f32 v177, v177
  v_mfma_f32_32x32x16_bf16 v[192:207], v[132:135], v[84:87], v[192:207]
  v_exp_f32 v178, v178
  v_exp_f32 v179, v179
  v_exp_f32 v180, v180
  v_mfma_f32_32x32x16_bf16 v[160:175], v[88:91], v[72:75], 0
  v_exp_f32 v181, v181
  v_exp_f32 v182, v182
  v_exp_f32 v183, v183
  v_cvt_pk_bf16_f32 v80, v176, v177
  v_cvt_pk_bf16_f32 v81, v178, v179
  v_cvt_pk_bf16_f32 v82, v180, v181
  v_cvt_pk_bf16_f32 v83, v182, v183
  v_exp_f32 v184, v184
  v_exp_f32 v185, v185
  v_mfma_f32_32x32x16_bf16 v[208:223], v[136:139], v[80:83], v[208:223]
  v_exp_f32 v186, v186
  v_exp_f32 v187, v187
  v_exp_f32 v188, v188
  v_exp_f32 v189, v189
  v_exp_f32 v190, v190
  v_exp_f32 v191, v191
  s_cmp_eq_u32 s6, 5
  v_cvt_pk_bf16_f32 v84, v184, v185
  v_cvt_pk_bf16_f32 v85, v186, v187
  v_cvt_pk_bf16_f32 v86, v188, v189
  v_cvt_pk_bf16_f32 v87, v190, v191
  s_cbranch_scc1 L_ax1
  v_exp_f32 v160, v160
  v_exp_f32 v161, v161
  v_mfma_f32_32x32x16_bf16 v[208:223], v[140:143], v[84:87], v[208:223]
  v_exp_f32 v162, v162
  v_exp_f32 v163, v163
  v_exp_f32 v164, v164
  s_waitcnt lgkmcnt(0)
  v_mfma_f32_32x32x16_bf16 v[176:191], v[92:95], v[76:79], 0
  s_mov_b64 exec, s[60:61]
  ds_read_b128 v[128:131], v45 offset:2048
  ds_read_b128 v[132:135], v45 offset:2560
  ds_read_b128 v[136:139], v45 offset:26624
  ds_read_b128 v[140:143], v45 offset:27136
  s_mov_b64 exec, -1
  ds_read_b128 v[244:247], v44 offset:26624
  ds_read_b128 v[88:91], v44 offset:0
  v_exp_f32 v165, v165
  v_exp_f32 v166, v166
  v_exp_f32 v167, v167
  v_cvt_pk_bf16_f32 v80, v160, v161
  v_cvt_pk_bf16_f32 v81, v162, v163
  v_cvt_pk_bf16_f32 v82, v164, v165
  v_cvt_pk_bf16_f32 v83, v166, v167
  v_exp_f32 v168, v168
  v_exp_f32 v169, v169
  v_mfma_f32_32x32x16_bf16 v[192:207], v[144:147], v[80:83], v[192:207]
  v_exp_f32 v170, v170
  v_exp_f32 v171, v171
  v_exp_f32 v172, v172
  v_exp_f32 v173, v173
  v_exp_f32 v174, v174
  v_exp_f32 v175, v175
  v_cvt_pk_bf16_f32 v84, v168, v169
  v_cvt_pk_bf16_f32 v85, v170, v171
  v_cvt_pk_bf16_f32 v86, v172, v173
  v_cvt_pk_bf16_f32 v87, v174, v175
  v_exp_f32 v176, v176
  v_exp_f32 v177, v177
  v_mfma_f32_32x32x16_bf16 v[192:207], v[148:151], v[84:87], v[192:207]
  v_exp_f32 v178, v178
  v_exp_f32 v179, v179
  v_exp_f32 v180, v180
  v_mfma_f32_32x32x16_bf16 v[160:175], v[240:243], v[72:75], 0
  v_exp_f32 v181, v181
  v_exp_f32 v182, v182
  v_exp_f32 v183, v183
  v_cvt_pk_bf16_f32 v80, v176, v177
  v_cvt_pk_bf16_f32 v81, v178, v179
  v_cvt_pk_bf16_f32 v82, v180, v181
  v_cvt_pk_bf16_f32 v83, v182, v183
  v_exp_f32 v184, v184
  v_exp_f32 v185, v185
  v_mfma_f32_32x32x16_bf16 v[208:223], v[152:155], v[80:83], v[208:223]
  v_exp_f32 v186, v186
  v_exp_f32 v187, v187
  v_exp_f32 v188, v188
  v_exp_f32 v189, v189
  v_exp_f32 v190, v190
  v_exp_f32 v191, v191
  s_cmp_eq_u32 s6, 6
  v_cvt_pk_bf16_f32 v84, v184, v185
  v_cvt_pk_bf16_f32 v85, v186, v187
  v_cvt_pk_bf16_f32 v86, v188, v189
  v_cvt_pk_bf16_f32 v87, v190, v191
  s_cbranch_scc1 L_ax0
  v_exp_f32 v160, v160
  v_exp_f32 v161, v161
  v_mfma_f32_32x32x16_bf16 v[208:223], v[156:159], v[84:87], v[208:223]
  v_exp_f32 v162, v162
  v_exp_f32 v163, v163
  v_exp_f32 v164, v164
  s_waitcnt lgkmcnt(0)
  v_mfma_f32_32x32x16_bf16 v[176:191], v[244:247], v[76:79], 0
  s_mov_b64 exec, s[60:61]
  ds_read_b128 v[144:147], v45 offset:0
  ds_read_b128 v[148:151], v45 offset:512
  ds_read_b128 v[152:155], v45 offset:24576
  ds_read_b128 v[156:159], v45 offset:25088
  s_mov_b64 exec, -1
  ds_read_b128 v[92:95], v44 offset:24576
  v_exp_f32 v165, v165
  v_exp_f32 v166, v166
  v_exp_f32 v167, v167
  v_cvt_pk_bf16_f32 v80, v160, v161
  v_cvt_pk_bf16_f32 v81, v162, v163
  v_cvt_pk_bf16_f32 v82, v164, v165
  v_cvt_pk_bf16_f32 v83, v166, v167
  v_exp_f32 v168, v168
  v_exp_f32 v169, v169
  v_mfma_f32_32x32x16_bf16 v[192:207], v[128:131], v[80:83], v[192:207]
  v_exp_f32 v170, v170
  v_exp_f32 v171, v171
  v_exp_f32 v172, v172
  v_exp_f32 v173, v173
  v_exp_f32 v174, v174
  v_exp_f32 v175, v175
  v_cvt_pk_bf16_f32 v84, v168, v169
  v_cvt_pk_bf16_f32 v85, v170, v171
  v_cvt_pk_bf16_f32 v86, v172, v173
  v_cvt_pk_bf16_f32 v87, v174, v175
  v_exp_f32 v176, v176
  v_exp_f32 v177, v177
  v_mfma_f32_32x32x16_bf16 v[192:207], v[132:135], v[84:87], v[192:207]
  v_exp_f32 v178, v178
  v_exp_f32 v179, v179
  v_exp_f32 v180, v180
  v_mfma_f32_32x32x16_bf16 v[160:175], v[88:91], v[72:75], v[112:127]
  v_exp_f32 v181, v181
  v_exp_f32 v182, v182
  v_exp_f32 v183, v183
  v_cvt_pk_bf16_f32 v80, v176, v177
  v_cvt_pk_bf16_f32 v81, v178, v179
  v_cvt_pk_bf16_f32 v82, v180, v181
  v_cvt_pk_bf16_f32 v83, v182, v183
  v_exp_f32 v184, v184
  v_exp_f32 v185, v185
  v_mfma_f32_32x32x16_bf16 v[208:223], v[136:139], v[80:83], v[208:223]
  v_exp_f32 v186, v186
  v_exp_f32 v187, v187
  v_exp_f32 v188, v188
  v_exp_f32 v189, v189
  v_exp_f32 v190, v190
  v_exp_f32 v191, v191
  s_cmp_eq_u32 s6, 7
  v_cvt_pk_bf16_f32 v84, v184, v185
  v_cvt_pk_bf16_f32 v85, v186, v187
  v_cvt_pk_bf16_f32 v86, v188, v189
  v_cvt_pk_bf16_f32 v87, v190, v191
  s_cbranch_scc1 L_ax1
  v_exp_f32 v160, v160
  v_exp_f32 v161, v161
  v_mfma_f32_32x32x16_bf16 v[208:223], v[140:143], v[84:87], v[208:223]
  v_exp_f32 v162, v162
  v_exp_f32 v163, v163
  v_exp_f32 v164, v164
  s_waitcnt lgkmcnt(0)
  v_mfma_f32_32x32x16_bf16 v[176:191], v[92:95], v[76:79], v[112:127]
  v_exp_f32 v165, v165
  v_exp_f32 v166, v166
  v_exp_f32 v167, v167
  v_cvt_pk_bf16_f32 v80, v160, v161
  v_cvt_pk_bf16_f32 v81, v162, v163
  v_cvt_pk_bf16_f32 v82, v164, v165
  v_cvt_pk_bf16_f32 v83, v166, v167
  v_exp_f32 v168, v168
  v_exp_f32 v169, v169
  v_mfma_f32_32x32x16_bf16 v[192:207], v[144:147], v[80:83], v[192:207]
  v_exp_f32 v170, v170
  v_exp_f32 v171, v171
  v_exp_f32 v172, v172
  v_exp_f32 v173, v173
  v_exp_f32 v174, v174
  v_exp_f32 v175, v175
  v_cvt_pk_bf16_f32 v84, v168, v169
  v_cvt_pk_bf16_f32 v85, v170, v171
  v_cvt_pk_bf16_f32 v86, v172, v173
  v_cvt_pk_bf16_f32 v87, v174, v175
  v_exp_f32 v176, v176
  v_exp_f32 v177, v177
  v_mfma_f32_32x32x16_bf16 v[192:207], v[148:151], v[84:87], v[192:207]
  v_exp_f32 v178, v178
  v_exp_f32 v179, v179
  v_exp_f32 v180, v180
  v_exp_f32 v181, v181
  v_exp_f32 v182, v182
  v_exp_f32 v183, v183
  v_cvt_pk_bf16_f32 v80, v176, v177
  v_cvt_pk_bf16_f32 v81, v178, v179
  v_cvt_pk_bf16_f32 v82, v180, v181
  v_cvt_pk_bf16_f32 v83, v182, v183
  v_exp_f32 v184, v184
  v_exp_f32 v185, v185
  v_mfma_f32_32x32x16_bf16 v[208:223], v[152:155], v[80:83], v[208:223]
  v_exp_f32 v186, v186
  v_exp_f32 v187, v187
  v_exp_f32 v188, v188
  v_exp_f32 v189, v189
  v_exp_f32 v190, v190
  v_exp_f32 v191, v191
  v_cvt_pk_bf16_f32 v84, v184, v185
  v_cvt_pk_bf16_f32 v85, v186, v187
  v_cvt_pk_bf16_f32 v86, v188, v189
  v_cvt_pk_bf16_f32 v87, v190, v191
L_ax0:
  s_nop 1
  v_mfma_f32_32x32x16_bf16 v[208:223], v[156:159], v[84:87], v[208:223]
L_att_e:
  v_cmp_nle_f32 vcc, 0x21800000, v200
  v_cmp_nge_f32 s[64:65], s13, v200
  v_rcp_f32 v6, v200
  s_nop 2
  s_or_b64 vcc, vcc, s[64:65]
  s_cbranch_scc1 L_afb0
L_afb0_r:
  s_nop 5
  v_mul_f32 v192, v6, v192
  v_mul_f32 v193, v6, v193
  v_mul_f32 v194, v6, v194
  v_mul_f32 v195, v6, v195
  v_mul_f32 v196, v6, v196
  v_mul_f32 v197, v6, v197
  v_mul_f32 v198, v6, v198
  v_mul_f32 v199, v6, v199
  v_cvt_pk_bf16_f32 v200, v192, v193
  v_cvt_pk_bf16_f32 v201, v194, v195
  v_cvt_pk_bf16_f32 v202, v196, v197
  v_cvt_pk_bf16_f32 v203, v198, v199
  buffer_store_dwordx4 v[200:203], v2, s[36:39], s4 offen offset:0 sc1
  v_cmp_nle_f32 vcc, 0x21800000, v216
  v_cmp_nge_f32 s[64:65], s13, v216
  v_rcp_f32 v6, v216
  s_nop 2
  s_or_b64 vcc, vcc, s[64:65]
  s_cbranch_scc1 L_afb1
L_afb1_r:
  s_nop 5
  v_mul_f32 v208, v6, v208
  v_mul_f32 v209, v6, v209
  v_mul_f32 v210, v6, v210
  v_mul_f32 v211, v6, v211
  v_mul_f32 v212, v6, v212
  v_mul_f32 v213, v6, v213
  v_mul_f32 v214, v6, v214
  v_mul_f32 v215, v6, v215
  v_cvt_pk_bf16_f32 v216, v208, v209
  v_cvt_pk_bf16_f32 v217, v210, v211
  v_cvt_pk_bf16_f32 v218, v212, v213
  v_cvt_pk_bf16_f32 v219, v214, v215
  buffer_store_dwordx4 v[216:219], v2, s[36:39], s4 offen offset:1024 sc1
  s_waitcnt vmcnt(0)
  s_mov_b64 exec, 1
  buffer_store_dword v14, v15, s[36:39], s5 offen sc1
  s_endpgm
L_qA:
  s_mov_b64 exec, 1
  buffer_load_dword v13, v15, s[36:39], s8 offen sc1
  s_mov_b64 exec, -1
  v_mfma_f32_32x32x16_bf16 v[160:175], v[56:59], v[64:67], 0
  v_mfma_f32_32x32x16_bf16 v[176:191], v[60:63], v[68:71], 0
  v_add_u32 v4, s72, v2
  s_nop 2
  v_mul_f32 v80, s10, v80
  v_mul_f32 v81, s10, v81
  v_mul_f32 v82, s10, v82
  v_mul_f32 v83, s10, v83
  v_mul_f32 v84, s10, v84
  v_mul_f32 v85, s10, v85
  v_mul_f32 v86, s10, v86
  v_mul_f32 v87, s10, v87
  v_mul_f32 v88, s10, v88
  v_mul_f32 v89, s10, v89
  v_mul_f32 v90, s10, v90
  v_mul_f32 v91, s10, v91
  v_mul_f32 v92, s10, v92
  v_mul_f32 v93, s10, v93
  v_mul_f32 v94, s10, v94
  v_mul_f32 v95, s10, v95
  v_cvt_pk_bf16_f32 v80, v80, v81
  v_cvt_pk_bf16_f32 v81, v82, v83
  v_cvt_pk_bf16_f32 v82, v84, v85
  v_cvt_pk_bf16_f32 v83, v86, v87
  v_cvt_pk_bf16_f32 v84, v88, v89
  v_cvt_pk_bf16_f32 v85, v90, v91
  v_cvt_pk_bf16_f32 v86, v92, v93
  v_cvt_pk_bf16_f32 v87, v94, v95
  v_mfma_f32_32x32x16_bf16 v[192:207], v[48:51], v[80:83], 0
  s_nop 0
  v_mfma_f32_32x32x16_bf16 v[208:223], v[52:55], v[84:87], 0
  v_max3_f32 v16, |v160|, |v161|, |v162|
  v_max3_f32 v16, v16, |v163|, |v164|
  v_max3_f32 v16, v16, |v165|, |v166|
  v_max3_f32 v16, v16, |v167|, |v176|
  v_max3_f32 v16, v16, |v177|, |v178|
  v_max3_f32 v16, v16, |v179|, |v180|
  v_max3_f32 v16, v16, |v181|, |v182|
  v_max_f32_e64 v16, v16, |v183|
  v_cmp_nge_f32 vcc, 0x42700000, v16
  s_nop 4
  s_cbranch_vccnz L_qg4
L_qg4_r:
  v_exp_f32 v160, v160
  v_exp_f32 v161, v161
  v_exp_f32 v162, v162
  v_exp_f32 v163, v163
  v_exp_f32 v164, v164
  v_exp_f32 v165, v165
  v_exp_f32 v166, v166
  v_exp_f32 v167, v167
  v_exp_f32 v168, v168
  v_exp_f32 v169, v169
  v_exp_f32 v170, v170
  v_exp_f32 v171, v171
  v_exp_f32 v172, v172
  v_exp_f32 v173, v173
  v_exp_f32 v174, v174
  v_exp_f32 v175, v175
  v_cvt_pk_bf16_f32 v160, v160, v161
  v_cvt_pk_bf16_f32 v161, v162, v163
  v_cvt_pk_bf16_f32 v162, v164, v165
  v_cvt_pk_bf16_f32 v163, v166, v167
  v_cvt_pk_bf16_f32 v164, v168, v169
  v_cvt_pk_bf16_f32 v165, v170, v171
  v_cvt_pk_bf16_f32 v166, v172, v173
  v_cvt_pk_bf16_f32 v167, v174, v175
  v_exp_f32 v176, v176
  v_exp_f32 v177, v177
  v_exp_f32 v178, v178
  v_exp_f32 v179, v179
  v_exp_f32 v180, v180
  v_exp_f32 v181, v181
  v_exp_f32 v182, v182
  v_exp_f32 v183, v183
  v_exp_f32 v184, v184
  v_exp_f32 v185, v185
  v_exp_f32 v186, v186
  v_exp_f32 v187, v187
  v_exp_f32 v188, v188
  v_exp_f32 v189, v189
  v_exp_f32 v190, v190
  v_exp_f32 v191, v191
  v_cvt_pk_bf16_f32 v176, v176, v177
  v_cvt_pk_bf16_f32 v177, v178, v179
  v_cvt_pk_bf16_f32 v178, v180, v181
  v_cvt_pk_bf16_f32 v179, v182, v183
  v_cvt_pk_bf16_f32 v180, v184, v185
  v_cvt_pk_bf16_f32 v181, v186, v187
  v_cvt_pk_bf16_f32 v182, v188, v189
  v_cvt_pk_bf16_f32 v183, v190, v191
  v_max3_f32 v16, |v192|, |v193|, |v194|
  v_max3_f32 v16, v16, |v195|, |v196|
  v_max3_f32 v16, v16, |v197|, |v198|
  v_max3_f32 v16, v16, |v199|, |v208|
  v_max3_f32 v16, v16, |v209|, |v210|
  v_max3_f32 v16, v16, |v211|, |v212|
  v_max3_f32 v16, v16, |v213|, |v214|
  v_max_f32_e64 v16, v16, |v215|
  v_cmp_nge_f32 vcc, 0x42700000, v16
  s_nop 4
  s_cbranch_vccnz L_qg5
L_qg5_r:
  s_barrier
  ds_write_b128 v4, v[160:163] offset:16384
  v_exp_f32 v192, v192
  v_exp_f32 v193, v193
  v_exp_f32 v194, v194
  v_exp_f32 v195, v195
  v_exp_f32 v196, v196
  v_exp_f32 v197, v197
  v_exp_f32 v198, v198
  v_exp_f32 v199, v199
  ds_write_b128 v4, v[164:167] offset:17408
  v_exp_f32 v200, v200
  v_exp_f32 v201, v201
  v_exp_f32 v202, v202
  v_exp_f32 v203, v203
  v_exp_f32 v204, v204
  v_exp_f32 v205, v205
  v_exp_f32 v206, v206
  v_exp_f32 v207, v207
  ds_write_b128 v4, v[176:179] offset:49152
  v_cvt_pk_bf16_f32 v192, v192, v193
  v_cvt_pk_bf16_f32 v193, v194, v195
  v_cvt_pk_bf16_f32 v194, v196, v197
  v_cvt_pk_bf16_f32 v195, v198, v199
  v_cvt_pk_bf16_f32 v196, v200, v201
  v_cvt_pk_bf16_f32 v197, v202, v203
  v_cvt_pk_bf16_f32 v198, v204, v205
  v_cvt_pk_bf16_f32 v199, v206, v207
  s_waitcnt vmcnt(0)
  s_mov_b64 exec, 1
  v_cmpx_ne_u32 vcc, s56, v13
  s_nop 4
  s_cbranch_execnz L_sp6
L_sp6_ok:
  s_mov_b64 exec, -1
  buffer_load_dwordx4 v[72:75], v2, s[36:39], s7 offen offset:0 sc1
  buffer_load_dwordx4 v[76:79], v2, s[36:39], s7 offen offset:1024 sc1
  ds_write_b128 v4, v[180:183] offset:50176
  v_exp_f32 v208, v208
  v_exp_f32 v209, v209
  v_exp_f32 v210, v210
  v_exp_f32 v211, v211
  v_exp_f32 v212, v212
  v_exp_f32 v213, v213
  v_exp_f32 v214, v214
  v_exp_f32 v215, v215
  ds_write_b128 v4, v[192:195] offset:0
  v_exp_f32 v216, v216
  v_exp_f32 v217, v217
  v_exp_f32 v218, v218
  v_exp_f32 v219, v219
  v_exp_f32 v220, v220
  v_exp_f32 v221, v221
  v_exp_f32 v222, v222
  v_exp_f32 v223, v223
  ds_write_b128 v4, v[196:199] offset:1024
  v_cvt_pk_bf16_f32 v208, v208, v209
  v_cvt_pk_bf16_f32 v209, v210, v211
  v_cvt_pk_bf16_f32 v210, v212, v213
  v_cvt_pk_bf16_f32 v211, v214, v215
  v_cvt_pk_bf16_f32 v212, v216, v217
  v_cvt_pk_bf16_f32 v213, v218, v219
  v_cvt_pk_bf16_f32 v214, v220, v221
  v_cvt_pk_bf16_f32 v215, v222, v223
  ds_write_b128 v4, v[208:211] offset:32768
  ds_write_b128 v4, v[212:215] offset:33792
  s_waitcnt lgkmcnt(0)
  s_mov_b64 exec, 15
  ds_write_b32 v8, v14 offset:16
  s_mov_b64 exec, -1
  v_and_b32 v4, 3, v1
  v_lshlrev_b32 v4, 2, v4
  v_add_u32 v4, 113696, v4
  ds_read_b32 v5, v4
  s_waitcnt lgkmcnt(0)
  v_cmp_ne_u32 vcc, s56, v5
  s_nop 4
  s_cbranch_vccnz L_lk
L_lk_ok:
  s_setprio 1
  s_waitcnt vmcnt(0)
  s_branch L_attgo
L_consumer:
  s_mov_b64 exec, -1
  v_and_b32 v1, 63, v0
  s_bfe_u32 s52, s2, 0x30003
  s_bfe_u32 s54, s2, 0x10006
  s_lshr_b32 s66, s2, 7
  s_and_b32 s53, s2, 7
  s_lshl_b32 s66, s66, 3
  s_add_u32 s52, s52, s66
  s_memrealtime s[62:63]
  v_lshlrev_b32 v2, 4, v1
  v_mov_b32 v15, 0
  s_or_b32 s64, s2, s55
  s_cmp_lg_u32 s64, 0
  s_waitcnt lgkmcnt(0)
  s_cbranch_scc1 L_nononce
  s_or_b32 s62, s62, 1
  v_mov_b32 v4, s62
  s_mov_b64 exec, 1
  global_store_dword v15, v4, s[22:23] sc1
  s_mov_b64 exec, -1
L_nononce:
  s_mov_b32 s40, s10
  s_mov_b32 s41, s11
  s_mov_b32 s42, 0x80000
  s_mov_b32 s43, 0x20000
  s_mov_b32 s44, s16
  s_mov_b32 s45, s17
  s_mov_b32 s46, 0x80000
  s_mov_b32 s47, 0x20000
  s_mov_b32 s48, s20
  s_mov_b32 s49, s21
  s_mov_b32 s50, 0x200000
  s_mov_b32 s51, 0x20000
  v_and_b32 v3, 31, v1
  v_lshrrev_b32 v6, 5, v1
  v_bfe_u32 v7, v1, 4, 1
  v_bfe_u32 v11, v1, 2, 2
  v_lshl_add_u32 v9, v6, 2, v11
  v_and_b32 v10, 3, v1
  v_lshlrev_b32 v0, 3, v3
  s_mov_b32 s38, 0x1000000
  s_mov_b32 s39, 0x20000
  s_mov_b32 s60, 0xffff
  s_mov_b32 s61, 0xffff
  s_and_b32 s57, s55, 1
  s_bfe_u32 s58, s55, 0x10001
  s_getreg_b32 s63, hwreg(HW_REG_XCC_ID, 0, 4)
  s_lshl_b32 s3, s53, 8
  s_add_u32 s3, s3, 0x960000
  s_sub_u32 s64, 3, s54
  s_mul_i32 s65, s64, s58
  s_lshl_b32 s67, s52, 1
  s_sub_i32 s68, 4, s67
  s_sub_i32 s66, s68, s65
  s_max_i32 s66, s66, 0
  s_min_i32 s66, s66, s64
  s_sub_u32 s64, s64, s66
  s_bfm_b64 s[30:31], s64, s66
  s_mul_i32 s13, s57, 24576
  s_lshl_b32 s66, s65, 12
  s_add_u32 s13, s13, s66
  s_add_u32 s13, s13, 49152
  s_sub_i32 s65, s65, s68
  s_sub_u32 s64, 1, s54
  s_lshl_b32 s66, s53, 1
  s_add_u32 s66, s66, s64
  s_lshl_b32 s67, s66, 5
  s_add_u32 s67, s67, s65
  s_lshl_b32 s9, s67, 7
  s_add_u32 s9, s9, 0x900000
  s_lshl_b32 s66, s66, 1
  s_add_u32 s66, s66, s57
  s_lshl_b32 s66, s66, 5
  s_add_u32 s66, s66, s65
  s_lshl_b32 s12, s66, 12
  s_add_u32 s12, s12, 0x4000
  s_lshl_b32 s65, s53, 1
  s_add_u32 s65, s65, s57
  s_lshl_b32 s66, s65, 5
  s_add_u32 s66, s66, s52
  s_lshl_b32 s66, s66, 1
  s_add_u32 s66, s66, s58
  s_lshl_b32 s6, s66, 12
  s_add_u32 s6, s6, 0x4000
  s_lshl_b32 s65, s65, 4
  s_add_u32 s65, s65, s52
  s_lshl_b32 s65, s65, 1
  s_add_u32 s65, s65, s58
  s_lshl_b32 s8, s65, 7
  s_add_u32 s8, s8, 0x900000
  s_lshl_b32 s69, s53, 1
  s_add_u32 s69, s69, s57
  s_lshl_b32 s69, s69, 1
  s_add_u32 s69, s69, s58
  s_lshl_b32 s67, s69, 4
  s_add_u32 s67, s67, s52
  s_lshl_b32 s11, s67, 7
  s_add_u32 s11, s11, 0x920000
  s_mul_i32 s10, s69, 18432
  s_lshl_b32 s66, s52, 10
  s_add_u32 s10, s10, s66
  s_add_u32 s10, s10, 0x820000
  s_mul_i32 s68, s52, 896
  s_sub_u32 s68, 16384, s68
  s_add_u32 s7, s6, 131072
  s_lshl_b32 s14, s69, 11
  s_add_u32 s14, s14, 0x920000
  s_mul_i32 s15, s69, 18432
  s_mov_b32 s21, s68
  s_add_u32 s15, s15, 0x820000
  s_lshl_b32 s66, s52, 8
  s_add_u32 s66, s66, s69
  s_lshl_b32 s16, s66, 10
  s_add_u32 s16, s16, 0x410000
  s_andn2_b32 s66, s66, 3
  s_lshl_b32 s17, s66, 7
  s_add_u32 s17, s17, 0x980000
  s_lshl_b32 s65, s52, 5
  s_add_u32 s65, s65, s69
  s_lshl_b32 s20, s65, 5
  s_add_u32 s20, s20, 0x940000
  s_lshl_b32 s65, s65, 12
  s_add_u32 s4, s4, s65
  s_addc_u32 s5, s5, 0
  v_and_b32 v5, 15, v1
  v_lshrrev_b32 v4, 1, v5
  v_lshrrev_b32 v8, 4, v1
  v_xor_b32 v4, v4, v8
  v_lshlrev_b32 v4, 4, v4
  v_lshl_add_u32 v4, v5, 7, v4
  s_lshl_b32 s65, s58, 13
  v_add_u32 v16, s65, v4
  v_xor_b32 v17, 64, v16
  v_lshl_add_u32 v5, v8, 3, v11
  v_lshlrev_b32 v5, 7, v5
  v_lshrrev_b32 v4, 1, v11
  v_xor_b32 v4, s57, v4
  v_lshl_add_u32 v5, v4, 6, v5
  v_lshl_add_u32 v5, v7, 5, v5
  v_lshl_add_u32 v20, v10, 3, v5
  v_add_u32 v20, 24576, v20
  v_xor_b32 v60, 32, v20
  v_and_b32 v4, 1, v10
  v_lshl_add_u32 v5, v4, 4, v5
  v_lshrrev_b32 v4, 1, v10
  v_lshl_add_u32 v5, v4, 3, v5
  v_add_u32 v18, 16384, v5
  v_xor_b32 v19, 32, v18
  v_and_b32 v4, 0x33, v1
  v_bfe_u32 v5, v1, 2, 1
  v_lshl_or_b32 v4, v5, 3, v4
  v_bfe_u32 v5, v1, 3, 1
  v_lshl_or_b32 v4, v5, 2, v4
  v_lshlrev_b32 v61, 4, v4
  v_lshlrev_b32 v4, 5, v9
  v_lshl_add_u32 v4, v10, 3, v4
  s_lshl_b32 s66, s57, 10
  s_add_u32 s66, s66, 161792
  v_add_u32 v52, s66, v4
  v_lshlrev_b32 v35, 15, v7
  v_lshl_or_b32 v35, v7, 31, v35
  v_and_b32 v5, 15, v1
  v_lshlrev_b32 v26, 7, v5
  v_lshlrev_b32 v5, 4, v5
  v_lshl_add_u32 v21, v6, 8, v5
  v_lshl_add_u32 v24, v7, 17, v21
  v_lshl_add_u32 v4, v6, 5, s21
  v_cmp_eq_u32 vcc, 16, v3
  s_nop 1
  v_cndmask_b32_e64 v25, v2, v4, vcc
  v_subrev_u32 v4, 240, v4
  v_cndmask_b32_e64 v54, v2, v4, vcc
  v_lshl_add_u32 v4, v6, 1, v7
  v_lshl_add_u32 v4, v4, 4, v26
  v_add_u32 v55, 16384, v4
  s_lshl_b32 s66, s55, 14
  s_add_u32 s66, s66, 98304
  v_add_u32 v32, s66, v2
  s_and_b32 s64, s2, 7
  s_lshl_b32 s64, s64, 2
  s_lshr_b32 s67, s2, 6
  s_add_u32 s64, s64, s67
  s_bfe_u32 s65, s2, 0x30003
  s_lshl_b32 s64, s64, 1
  s_add_u32 s64, s64, s57
  s_lshl_b32 s26, s64, 8
  s_add_u32 s26, s26, 0x940000
  s_lshl_b32 s27, s64, 15
  s_lshl_b32 s65, s65, 7
  s_add_u32 s27, s27, s65
  s_lshl_b32 s66, s58, 6
  s_add_u32 s27, s27, s66
  s_lshl_b32 s64, s64, 2
  s_add_u32 s64, s64, s58
  s_lshl_b32 s24, s64, 14
  s_add_u32 s24, s24, 0x410000
  s_lshl_b32 s25, s64, 11
  s_add_u32 s25, s25, 0x980000
  v_lshrrev_b32 v4, 3, v1
  v_and_b32 v5, 7, v1
  v_lshlrev_b32 v8, 2, v7
  v_xor_b32 v5, v5, v8
  v_lshlrev_b32 v4, 10, v4
  v_lshl_add_u32 v4, v5, 4, v4
  v_add_u32 v27, s65, v4
  v_lshlrev_b32 v8, 7, v9
  v_lshrrev_b32 v4, 1, v11
  v_xor_b32 v4, s58, v4
  v_lshl_add_u32 v8, v4, 6, v8
  v_lshl_add_u32 v8, v7, 5, v8
  v_lshl_add_u32 v8, v10, 3, v8
  s_lshl_b32 s66, s58, 15
  s_add_u32 s66, s66, 98304
  v_add_u32 v28, s66, v8
  s_mul_i32 s66, s58, 24576
  v_add_u32 v29, s66, v8
  s_lshl_b32 s32, s55, 17
  s_lshl_b32 s33, s55, 14
  s_add_u32 s33, s33, 98304
  s_mul_i32 s35, s57, 12288
  s_lshl_b32 s34, s35, 3
  s_add_u32 s35, s35, s66
  s_lshl_b32 s67, s58, 18
  s_add_u32 s34, s34, s67
  s_lshl_b32 s29, s57, 12
  s_lshl_b32 s28, s29, 3
  s_add_u32 s28, s28, s67
  s_add_u32 s28, s28, 196608
  s_add_u32 s29, s29, s66
  s_add_u32 s29, s29, 65536
  s_lshl_b32 s66, s55, 12
  s_add_u32 s66, s66, 49152
  v_add_u32 v30, s66, v2
  v_lshlrev_b32 v4, 4, v6
  v_lshl_add_u32 v31, v3, 10, v4
  v_mov_b64 v[128:129], 0
  v_mov_b64 v[130:131], 0
  v_mov_b64 v[132:133], 0
  v_mov_b64 v[134:135], 0
  v_mov_b64 v[136:137], 0
  v_mov_b64 v[138:139], 0
  v_mov_b64 v[140:141], 0
  v_mov_b64 v[142:143], 0
  v_mov_b64 v[144:145], 0
  v_mov_b64 v[146:147], 0
  v_mov_b64 v[148:149], 0
  v_mov_b64 v[150:151], 0
  v_mov_b64 v[152:153], 0
  v_mov_b64 v[154:155], 0
  v_mov_b64 v[156:157], 0
  v_mov_b64 v[158:159], 0
  v_mov_b64 v[160:161], 0
  v_mov_b64 v[162:163], 0
  v_mov_b64 v[164:165], 0
  v_mov_b64 v[166:167], 0
  v_mov_b64 v[168:169], 0
  v_mov_b64 v[170:171], 0
  v_mov_b64 v[172:173], 0
  v_mov_b64 v[174:175], 0
  v_mov_b64 v[176:177], 0
  v_mov_b64 v[178:179], 0
  v_mov_b64 v[180:181], 0
  v_mov_b64 v[182:183], 0
  v_mov_b64 v[184:185], 0
  v_mov_b64 v[186:187], 0
  v_mov_b64 v[188:189], 0
  v_mov_b64 v[190:191], 0
  s_cmp_eq_u32 s54, 0
  s_cbranch_scc1 L_preA
  s_lshl_b32 s65, s58, 12
  s_add_u32 s65, s65, 65536
  v_add_u32 v22, s65, v61
  v_mul_u32_u24 v4, 24576, v7
  v_add3_u32 v23, v21, v4, s65
  s_branch L_predone
L_preA:
  s_lshl_b32 s65, s57, 14
  s_lshl_b32 s66, s58, 12
  s_add_u32 s65, s65, s66
  v_bfe_u32 v4, v3, 1, 2
  v_lshlrev_b32 v5, 1, v6
  v_xor_b32 v4, v4, v5
  v_lshlrev_b32 v4, 4, v4
  v_lshl_add_u32 v4, v3, 6, v4
  v_add_u32 v22, s65, v4
  v_xor_b32 v24, 16, v22
  s_lshr_b32 s65, s65, 1
  s_add_u32 s65, s65, 32768
  v_lshlrev_b32 v4, 12, v7
  v_add3_u32 v23, v21, v4, s65
  v_and_b32 v5, 1, v10
  v_lshl_add_u32 v5, v5, 1, v7
  v_lshrrev_b32 v4, 1, v11
  v_xor_b32 v5, v5, v4
  v_lshl_add_u32 v4, v6, 3, v11
  v_lshlrev_b32 v4, 6, v4
  v_lshl_add_u32 v4, v5, 4, v4
  v_lshrrev_b32 v5, 1, v10
  v_lshl_add_u32 v4, v5, 3, v4
  s_and_b32 s66, s69, 3
  s_lshl_b32 s65, s66, 13
  v_add_u32 v33, s65, v4
  v_xor_b32 v61, 32, v33
  s_lshl_b32 s65, s66, 12
  s_add_u32 s65, s65, 32768
  v_add_u32 v34, s65, v21
  v_lshlrev_b32 v4, 2, v6
  v_sub_u32 v4, v3, v4
  v_mov_b32 v5, 0x3f80
  v_mov_b32 v8, 1.0
  v_cmp_eq_u32 vcc, 0, v4
  v_cmp_eq_u32 s[64:65], 1, v4
  s_nop 0
  v_cndmask_b32_e64 v44, 0, v5, vcc
  v_cndmask_b32_e64 v44, v44, v8, s[64:65]
  v_cmp_eq_u32 vcc, 2, v4
  v_cmp_eq_u32 s[64:65], 3, v4
  s_nop 0
  v_cndmask_b32_e64 v45, 0, v5, vcc
  v_cndmask_b32_e64 v45, v45, v8, s[64:65]
  v_cmp_eq_u32 vcc, 8, v4
  v_cmp_eq_u32 s[64:65], 9, v4
  s_nop 0
  v_cndmask_b32_e64 v46, 0, v5, vcc
  v_cndmask_b32_e64 v46, v46, v8, s[64:65]
  v_cmp_eq_u32 vcc, 10, v4
  v_cmp_eq_u32 s[64:65], 11, v4
  s_nop 0
  v_cndmask_b32_e64 v47, 0, v5, vcc
  v_cndmask_b32_e64 v47, v47, v8, s[64:65]
  v_mov_b32 v4, 0x3f803f80
  v_mov_b32 v5, v4
  v_mov_b64 v[224:225], v[4:5]
  v_mov_b64 v[226:227], v[4:5]
  v_mov_b64 v[228:229], v[4:5]
  v_mov_b64 v[230:231], v[4:5]
  v_mov_b64 v[232:233], v[4:5]
  v_mov_b64 v[234:235], v[4:5]
  v_mov_b64 v[236:237], v[4:5]
  v_mov_b64 v[238:239], v[4:5]
  v_mov_b64 v[240:241], v[4:5]
  v_mov_b64 v[242:243], v[4:5]
  v_mov_b64 v[244:245], v[4:5]
  v_mov_b64 v[246:247], v[4:5]
  v_mov_b64 v[248:249], v[4:5]
  v_mov_b64 v[250:251], v[4:5]
  v_mov_b64 v[252:253], v[4:5]
  v_mov_b64 v[254:255], v[4:5]
L_predone:
  s_mov_b32 s64, 0
  s_mov_b32 s65, 0
  s_barrier
  ds_read_b64_tr_b16 v[36:37], v52 offset:0
  ds_read_b64_tr_b16 v[38:39], v52 offset:256
  ds_read_b64_tr_b16 v[40:41], v52 offset:512
  ds_read_b64_tr_b16 v[42:43], v52 offset:768
  ds_read_b128 v[96:99], v16 offset:0
  ds_read_b128 v[100:103], v17 offset:0
  ds_read_b64_tr_b16 v[64:65], v18 offset:0
  ds_read_b64_tr_b16 v[66:67], v18 offset:512
  ds_read_b64_tr_b16 v[68:69], v18 offset:4096
  ds_read_b64_tr_b16 v[70:71], v18 offset:4608
  ds_read_b64_tr_b16 v[72:73], v19 offset:0
  ds_read_b64_tr_b16 v[74:75], v19 offset:512
  ds_read_b64_tr_b16 v[76:77], v19 offset:4096
  ds_read_b64_tr_b16 v[78:79], v19 offset:4608
  global_load_dword v14, v15, s[22:23] sc1
  s_waitcnt lgkmcnt(4)
  ds_read_b64_tr_b16 v[80:81], v20 offset:0
  ds_read_b64_tr_b16 v[82:83], v20 offset:512
  ds_read_b64_tr_b16 v[84:85], v20 offset:4096
  ds_read_b64_tr_b16 v[86:87], v20 offset:4608
  ds_read_b64_tr_b16 v[88:89], v60 offset:0
  ds_read_b64_tr_b16 v[90:91], v60 offset:512
  ds_read_b64_tr_b16 v[92:93], v60 offset:4096
  ds_read_b64_tr_b16 v[94:95], v60 offset:4608
L_cloop:
  v_mfma_f32_16x16x32_bf16 v[128:131], v[64:67], v[96:99], v[128:131]
  ds_read_b128 v[104:107], v16 offset:2048
  ds_read_b128 v[108:111], v17 offset:2048
  v_mfma_f32_16x16x32_bf16 v[128:131], v[68:71], v[100:103], v[128:131]
  s_waitcnt lgkmcnt(10)
  v_mfma_f32_16x16x32_bf16 v[132:135], v[72:75], v[96:99], v[132:135]
  s_add_u32 s65, s65, 1
  s_cmp_eq_u32 s65, 5
  v_mfma_f32_16x16x32_bf16 v[132:135], v[76:79], v[100:103], v[132:135]
  s_mov_b32 s66, 32768
  s_cselect_b32 s66, 0xfffe0000, s66
  s_waitcnt lgkmcnt(6)
  v_mfma_f32_16x16x32_bf16 v[136:139], v[96:99], v[80:83], v[136:139]
  s_cselect_b32 s65, 0, s65
  v_mfma_f32_16x16x32_bf16 v[136:139], v[100:103], v[84:87], v[136:139]
  s_waitcnt lgkmcnt(2)
  v_mfma_f32_16x16x32_bf16 v[140:143], v[96:99], v[88:91], v[140:143]
  v_mfma_f32_16x16x32_bf16 v[140:143], v[100:103], v[92:95], v[140:143]
  s_waitcnt lgkmcnt(0)
  v_mfma_f32_16x16x32_bf16 v[144:147], v[64:67], v[104:107], v[144:147]
  ds_read_b128 v[96:99], v16 offset:4096
  ds_read_b128 v[100:103], v17 offset:4096
  v_mfma_f32_16x16x32_bf16 v[144:147], v[68:71], v[108:111], v[144:147]
  v_mfma_f32_16x16x32_bf16 v[148:151], v[72:75], v[104:107], v[148:151]
  v_add_u32 v18, s66, v18
  v_mfma_f32_16x16x32_bf16 v[148:151], v[76:79], v[108:111], v[148:151]
  v_add_u32 v19, s66, v19
  v_mfma_f32_16x16x32_bf16 v[152:155], v[104:107], v[80:83], v[152:155]
  v_add_u32 v20, s66, v20
  v_mfma_f32_16x16x32_bf16 v[152:155], v[108:111], v[84:87], v[152:155]
  v_add_u32 v60, s66, v60
  v_mfma_f32_16x16x32_bf16 v[156:159], v[104:107], v[88:91], v[156:159]
  v_mfma_f32_16x16x32_bf16 v[156:159], v[108:111], v[92:95], v[156:159]
  s_waitcnt lgkmcnt(0)
  v_mfma_f32_16x16x32_bf16 v[160:163], v[64:67], v[96:99], v[160:163]
  ds_read_b128 v[104:107], v16 offset:6144
  ds_read_b128 v[108:111], v17 offset:6144
  v_mfma_f32_16x16x32_bf16 v[160:163], v[68:71], v[100:103], v[160:163]
  v_mfma_f32_16x16x32_bf16 v[164:167], v[72:75], v[96:99], v[164:167]
  v_add_u32 v16, s66, v16
  v_mfma_f32_16x16x32_bf16 v[164:167], v[76:79], v[100:103], v[164:167]
  v_add_u32 v17, s66, v17
  v_mfma_f32_16x16x32_bf16 v[168:171], v[96:99], v[80:83], v[168:171]
  s_add_u32 s64, s64, 1
  s_cmp_eq_u32 s64, 8
  v_mfma_f32_16x16x32_bf16 v[168:171], v[100:103], v[84:87], v[168:171]
  v_mfma_f32_16x16x32_bf16 v[172:175], v[96:99], v[88:91], v[172:175]
  v_mfma_f32_16x16x32_bf16 v[172:175], v[100:103], v[92:95], v[172:175]
  s_waitcnt lgkmcnt(0)
  s_cbranch_scc1 L_clast
  s_barrier
  v_mfma_f32_16x16x32_bf16 v[176:179], v[64:67], v[104:107], v[176:179]
  ds_read_b128 v[96:99], v16 offset:0
  ds_read_b128 v[100:103], v17 offset:0
  v_mfma_f32_16x16x32_bf16 v[176:179], v[68:71], v[108:111], v[176:179]
  ds_read_b64_tr_b16 v[64:65], v18 offset:0
  ds_read_b64_tr_b16 v[66:67], v18 offset:512
  ds_read_b64_tr_b16 v[68:69], v18 offset:4096
  ds_read_b64_tr_b16 v[70:71], v18 offset:4608
  v_mfma_f32_16x16x32_bf16 v[180:183], v[72:75], v[104:107], v[180:183]
  v_mfma_f32_16x16x32_bf16 v[180:183], v[76:79], v[108:111], v[180:183]
  ds_read_b64_tr_b16 v[72:73], v19 offset:0
  ds_read_b64_tr_b16 v[74:75], v19 offset:512
  ds_read_b64_tr_b16 v[76:77], v19 offset:4096
  ds_read_b64_tr_b16 v[78:79], v19 offset:4608
  v_mfma_f32_16x16x32_bf16 v[184:187], v[104:107], v[80:83], v[184:187]
  v_mfma_f32_16x16x32_bf16 v[184:187], v[108:111], v[84:87], v[184:187]
  ds_read_b64_tr_b16 v[80:81], v20 offset:0
  ds_read_b64_tr_b16 v[82:83], v20 offset:512
  ds_read_b64_tr_b16 v[84:85], v20 offset:4096
  ds_read_b64_tr_b16 v[86:87], v20 offset:4608
  v_mfma_f32_16x16x32_bf16 v[188:191], v[104:107], v[88:91], v[188:191]
  s_bitcmp1_b32 s64, 0
  v_mfma_f32_16x16x32_bf16 v[188:191], v[108:111], v[92:95], v[188:191]
  s_waitcnt lgkmcnt(8)
  ds_read_b64_tr_b16 v[88:89], v60 offset:0
  ds_read_b64_tr_b16 v[90:91], v60 offset:512
  ds_read_b64_tr_b16 v[92:93], v60 offset:4096
  ds_read_b64_tr_b16 v[94:95], v60 offset:4608
  s_cbranch_scc1 L_cloop
  s_cmp_eq_u32 s64, 4
  s_cbranch_scc1 L_c4
  s_cmp_eq_u32 s64, 6
  s_cbranch_scc1 L_c6
  v_xor_b32 v36, v35, v36
  v_xor_b32 v37, v35, v37
  v_xor_b32 v38, v35, v38
  v_xor_b32 v39, v35, v39
  s_branch L_cloop
L_c4:
  v_xor_b32 v40, v35, v40
  v_xor_b32 v41, v35, v41
  v_xor_b32 v42, v35, v42
  v_xor_b32 v43, v35, v43
  s_branch L_cloop
L_c6:
  buffer_load_dwordx2 v[12:13], v0, s[36:39], s3 offen sc1
  s_branch L_cloop
L_clast:
  v_mfma_f32_16x16x32_bf16 v[176:179], v[64:67], v[104:107], v[176:179]
  v_mfma_f32_16x16x32_bf16 v[176:179], v[68:71], v[108:111], v[176:179]
  v_mfma_f32_16x16x32_bf16 v[180:183], v[72:75], v[104:107], v[180:183]
  v_mfma_f32_16x16x32_bf16 v[180:183], v[76:79], v[108:111], v[180:183]
  v_mfma_f32_16x16x32_bf16 v[184:187], v[104:107], v[80:83], v[184:187]
  v_mfma_f32_16x16x32_bf16 v[184:187], v[108:111], v[84:87], v[184:187]
  v_mfma_f32_16x16x32_bf16 v[188:191], v[104:107], v[88:91], v[188:191]
  v_mfma_f32_16x16x32_bf16 v[188:191], v[108:111], v[92:95], v[188:191]
  s_waitcnt vmcnt(0)
  v_readfirstlane_b32 s56, v14
  s_nop 3
  s_cmp_eq_u32 s56, 0
  s_cbranch_scc1 L_gn7
L_gn7_ok:
  v_cmp_ne_u32 vcc, s56, v13
  s_nop 4
  s_cbranch_vccnz L_xw8
L_xw8_ok:
  v_cmp_ne_u32 vcc, s63, v12
  s_nop 3
  s_cmp_eq_u64 vcc, 0
  s_cselect_b32 s62, 1, 0
  s_cmp_eq_u32 s54, 0
  s_cbranch_scc1 L_epiA
  v_cvt_pk_bf16_f32 v64, v128, v129
  v_cvt_pk_bf16_f32 v65, v130, v131
  v_cvt_pk_bf16_f32 v66, v144, v145
  v_cvt_pk_bf16_f32 v67, v146, v147
  v_cvt_pk_bf16_f32 v68, v132, v133
  v_cvt_pk_bf16_f32 v69, v134, v135
  v_cvt_pk_bf16_f32 v70, v148, v149
  v_cvt_pk_bf16_f32 v71, v150, v151
  v_permlane16_swap_b32 v64, v66
  v_permlane16_swap_b32 v65, v67
  v_permlane16_swap_b32 v68, v70
  v_permlane16_swap_b32 v69, v71
  buffer_store_dwordx4 v[64:67], v61, s[36:39], s6 offen offset:0 sc1
  buffer_store_dwordx4 v[68:71], v61, s[36:39], s7 offen offset:0 sc1
  v_cvt_pk_bf16_f32 v80, v136, v137
  v_cvt_pk_bf16_f32 v81, v138, v139
  v_cvt_pk_bf16_f32 v82, v140, v141
  v_cvt_pk_bf16_f32 v83, v142, v143
  v_cvt_pk_bf16_f32 v84, v152, v153
  v_cvt_pk_bf16_f32 v85, v154, v155
  v_cvt_pk_bf16_f32 v86, v156, v157
  v_cvt_pk_bf16_f32 v87, v158, v159
  v_permlane16_swap_b32 v80, v82
  v_permlane16_swap_b32 v81, v83
  v_permlane16_swap_b32 v84, v86
  v_permlane16_swap_b32 v85, v87
  buffer_store_dwordx4 v[80:83], v24, s[36:39], s6 offen offset:1024 sc1
  buffer_store_dwordx4 v[84:87], v24, s[36:39], s6 offen offset:1536 sc1
  v_cvt_pk_bf16_f32 v72, v160, v161
  v_cvt_pk_bf16_f32 v73, v162, v163
  v_cvt_pk_bf16_f32 v74, v176, v177
  v_cvt_pk_bf16_f32 v75, v178, v179
  v_cvt_pk_bf16_f32 v76, v164, v165
  v_cvt_pk_bf16_f32 v77, v166, v167
  v_cvt_pk_bf16_f32 v78, v180, v181
  v_cvt_pk_bf16_f32 v79, v182, v183
  v_permlane16_swap_b32 v72, v74
  v_permlane16_swap_b32 v73, v75
  v_permlane16_swap_b32 v76, v78
  v_permlane16_swap_b32 v77, v79
  buffer_store_dwordx4 v[72:75], v61, s[36:39], s6 offen offset:2048 sc1
  buffer_store_dwordx4 v[76:79], v61, s[36:39], s7 offen offset:2048 sc1
  s_barrier
  v_cvt_pk_bf16_f32 v88, v168, v169
  v_cvt_pk_bf16_f32 v89, v170, v171
  v_cvt_pk_bf16_f32 v90, v172, v173
  v_cvt_pk_bf16_f32 v91, v174, v175
  v_cvt_pk_bf16_f32 v92, v184, v185
  v_cvt_pk_bf16_f32 v93, v186, v187
  v_cvt_pk_bf16_f32 v94, v188, v189
  v_cvt_pk_bf16_f32 v95, v190, v191
  v_permlane16_swap_b32 v88, v90
  v_permlane16_swap_b32 v89, v91
  v_permlane16_swap_b32 v92, v94
  v_permlane16_swap_b32 v93, v95
  buffer_store_dwordx4 v[88:91], v24, s[36:39], s6 offen offset:3072 sc1
  buffer_store_dwordx4 v[92:95], v24, s[36:39], s6 offen offset:3584 sc1
  s_barrier
  global_load_dwordx4 v[128:131], v2, s[4:5] offset:0
  global_load_dwordx4 v[132:135], v2, s[4:5] offset:1024
  global_load_dwordx4 v[136:139], v2, s[4:5] offset:2048
  global_load_dwordx4 v[140:143], v2, s[4:5] offset:3072
  global_load_dwordx4 v[144:147], v2, s[18:19]
  s_cmp_eq_u32 s57, 1
  s_cbranch_scc1 L_noown
  ds_write_b128 v22, v[64:67] offset:0
  ds_write_b128 v22, v[68:71] offset:24576
  ds_write_b128 v23, v[80:83] offset:1024
  ds_write_b128 v23, v[84:87] offset:1536
  ds_write_b128 v22, v[72:75] offset:2048
  ds_write_b128 v22, v[76:79] offset:26624
  ds_write_b128 v23, v[88:91] offset:3072
  ds_write_b128 v23, v[92:95] offset:3584
L_noown:
  s_waitcnt vmcnt(5)
  s_mov_b64 exec, 1
  s_cmp_eq_u32 s62, 0
  s_cbranch_scc1 L_bo9
  buffer_store_dword v14, v15, s[36:39], s8 offen
L_bo9_r:
  s_mov_b64 exec, -1
  s_mov_b64 exec, s[30:31]
  s_cbranch_execz L_npb
  buffer_load_dword v13, v26, s[36:39], s9 offen sc1
L_npb:
  s_waitcnt vmcnt(0)
  s_mov_b64 exec, s[30:31]
  v_cmpx_ne_u32 vcc, s56, v13
  s_nop 4
  s_cbranch_execnz L_sp10
L_sp10_ok:
  s_mov_b64 exec, -1
  s_add_u32 s74, s12, 4096
  s_add_u32 m0, s13, 4096
  s_nop 0
  buffer_load_dwordx4 v2, s[36:39], s74 offen offset:0 sc1 lds
  buffer_load_dwordx4 v2, s[36:39], s74 offen offset:1024 sc1 lds
  buffer_load_dwordx4 v2, s[36:39], s74 offen offset:2048 sc1 lds
  buffer_load_dwordx4 v2, s[36:39], s74 offen offset:3072 sc1 lds
  s_add_u32 s74, s12, 0
  s_add_u32 m0, s13, 0
  s_nop 0
  buffer_load_dwordx4 v2, s[36:39], s74 offen offset:0 sc1 lds
  buffer_load_dwordx4 v2, s[36:39], s74 offen offset:1024 sc1 lds
  buffer_load_dwordx4 v2, s[36:39], s74 offen offset:2048 sc1 lds
  buffer_load_dwordx4 v2, s[36:39], s74 offen offset:3072 sc1 lds
  v_mov_b32 v148, 0
  v_mov_b32 v149, 0
  v_mov_b32 v150, 0
  v_mov_b32 v151, 0
  v_dot2c_f32_bf16 v148, v128, v144
  v_dot2c_f32_bf16 v149, v132, v144
  v_dot2c_f32_bf16 v150, v136, v144
  v_dot2c_f32_bf16 v151, v140, v144
  v_dot2c_f32_bf16 v148, v129, v145
  v_dot2c_f32_bf16 v149, v133, v145
  v_dot2c_f32_bf16 v150, v137, v145
  v_dot2c_f32_bf16 v151, v141, v145
  v_dot2c_f32_bf16 v148, v130, v146
  v_dot2c_f32_bf16 v149, v134, v146
  v_dot2c_f32_bf16 v150, v138, v146
  v_dot2c_f32_bf16 v151, v142, v146
  v_dot2c_f32_bf16 v148, v131, v147
  v_dot2c_f32_bf16 v149, v135, v147
  v_dot2c_f32_bf16 v150, v139, v147
  v_dot2c_f32_bf16 v151, v143, v147
  s_nop 1
  v_permlane32_swap_b32 v148, v150
  v_permlane32_swap_b32 v149, v151
  v_add_f32 v148, v148, v150
  v_add_f32 v149, v149, v151
  s_nop 1
  v_permlane16_swap_b32 v148, v149
  v_add_f32 v148, v148, v149
  s_nop 1
  v_add_f32_dpp v148, v148, v148 quad_perm:[1,0,3,2] row_mask:0xf bank_mask:0xf
  s_nop 1
  v_add_f32_dpp v148, v148, v148 quad_perm:[2,3,0,1] row_mask:0xf bank_mask:0xf
  s_nop 1
  v_add_f32_dpp v148, v148, v148 row_half_mirror row_mask:0xf bank_mask:0xf
  s_nop 1
  v_add_f32_dpp v148, v148, v148 row_mirror row_mask:0xf bank_mask:0xf
  v_mul_f32 v148, 0xbfb8aa3b, v148
  v_exp_f32 v148, v148
  s_nop 0
  v_add_f32 v148, 1.0, v148
  v_rcp_f32 v148, v148
  v_mov_b32 v149, v14
  v_lshrrev_b32 v4, 1, v1
  s_mov_b32 exec_lo, 0x10001
  s_mov_b32 exec_hi, 0x10001
  buffer_store_dwordx2 v[148:149], v4, s[36:39], s20 offen sc1
  s_mov_b64 exec, -1
  s_waitcnt vmcnt(1) lgkmcnt(0)
  s_barrier
  s_and_b32 s77, s2, 7
  s_lshl_b32 s76, s77, 1
  s_cmp_ge_u32 s2, 128
  s_cbranch_scc1 L_wB1
  s_lshl_b32 s79, s76, 10
  s_mov_b32 s82, 15
L_wo11:
  s_lshl_b32 s80, s79, 3
  s_add_u32 m0, s79, s33
  s_add_u32 s80, s80, s32
  s_add_u32 s79, s79, 1024
  buffer_load_dwordx4 v27, s[40:43], s80 offen lds
  s_cmp_eq_u32 s79, 15360
  s_cselect_b32 s79, 0, s79
  s_sub_u32 s82, s82, 1
  s_cmp_lg_u32 s82, 0
  s_cbranch_scc1 L_wo11
L_wB1:
  s_lshl_b32 s79, s77, 10
  s_mov_b32 s82, 12
L_wo12:
  s_lshl_b32 s80, s79, 3
  s_add_u32 m0, s79, s35
  s_add_u32 s80, s80, s34
  s_add_u32 s79, s79, 1024
  buffer_load_dwordx4 v27, s[44:47], s80 offen lds
  s_cmp_eq_u32 s79, 12288
  s_cselect_b32 s79, 0, s79
  s_sub_u32 s82, s82, 1
  s_cmp_lg_u32 s82, 0
  s_cbranch_scc1 L_wo12
  s_cmp_lt_u32 s2, 128
  s_cbranch_scc1 L_wB2
  s_lshl_b32 s79, s76, 10
  s_mov_b32 s82, 15
L_wo13:
  s_lshl_b32 s80, s79, 3
  s_add_u32 m0, s79, s33
  s_add_u32 s80, s80, s32
  s_add_u32 s79, s79, 1024
  buffer_load_dwordx4 v27, s[40:43], s80 offen lds
  s_cmp_eq_u32 s79, 15360
  s_cselect_b32 s79, 0, s79
  s_sub_u32 s82, s82, 1
  s_cmp_lg_u32 s82, 0
  s_cbranch_scc1 L_wo13
L_wB2:
  v_bfe_u32 v4, v1, 4, 1
  s_and_b32 s77, s25, 24576
  s_andn2_b32 s25, s25, 0x6000
  s_add_u32 s77, s77, 4096
  v_mul_u32_u24 v4, s77, v4
  v_add_u32 v11, v4, v26
  buffer_load_dwordx2 v[6:7], v0, s[36:39], s26 offen sc1
  s_branch L_tail
L_epiA:
  s_mov_b32 s68, 0x3fb8aa3b
  v_mul_f32 v128, s68, v128
  v_mul_f32 v129, s68, v129
  v_mul_f32 v130, s68, v130
  v_mul_f32 v131, s68, v131
  v_mul_f32 v132, s68, v132
  v_mul_f32 v133, s68, v133
  v_mul_f32 v134, s68, v134
  v_mul_f32 v135, s68, v135
  v_mul_f32 v144, s68, v144
  v_mul_f32 v145, s68, v145
  v_mul_f32 v146, s68, v146
  v_mul_f32 v147, s68, v147
  v_mul_f32 v148, s68, v148
  v_mul_f32 v149, s68, v149
  v_mul_f32 v150, s68, v150
  v_mul_f32 v151, s68, v151
  v_cvt_pk_bf16_f32 v64, v128, v129
  v_cvt_pk_bf16_f32 v65, v130, v131
  v_cvt_pk_bf16_f32 v66, v144, v145
  v_cvt_pk_bf16_f32 v67, v146, v147
  v_cvt_pk_bf16_f32 v68, v132, v133
  v_cvt_pk_bf16_f32 v69, v134, v135
  v_cvt_pk_bf16_f32 v70, v148, v149
  v_cvt_pk_bf16_f32 v71, v150, v151
  v_permlane16_swap_b32 v64, v66
  v_permlane16_swap_b32 v65, v67
  v_permlane16_swap_b32 v68, v70
  v_permlane16_swap_b32 v69, v71
  v_mfma_f32_32x32x16_bf16 v[192:207], v[36:39], v[64:67], 0
  s_nop 0
  v_mfma_f32_32x32x16_bf16 v[208:223], v[40:43], v[68:71], 0
  v_mul_f32 v160, s68, v160
  v_mul_f32 v161, s68, v161
  v_mul_f32 v162, s68, v162
  v_mul_f32 v163, s68, v163
  v_mul_f32 v164, s68, v164
  v_mul_f32 v165, s68, v165
  v_mul_f32 v166, s68, v166
  v_mul_f32 v167, s68, v167
  v_mul_f32 v176, s68, v176
  v_mul_f32 v177, s68, v177
  v_mul_f32 v178, s68, v178
  v_mul_f32 v179, s68, v179
  v_mul_f32 v180, s68, v180
  v_mul_f32 v181, s68, v181
  v_mul_f32 v182, s68, v182
  v_mul_f32 v183, s68, v183
  v_cvt_pk_bf16_f32 v72, v160, v161
  v_cvt_pk_bf16_f32 v73, v162, v163
  v_cvt_pk_bf16_f32 v74, v176, v177
  v_cvt_pk_bf16_f32 v75, v178, v179
  v_cvt_pk_bf16_f32 v76, v164, v165
  v_cvt_pk_bf16_f32 v77, v166, v167
  v_cvt_pk_bf16_f32 v78, v180, v181
  v_cvt_pk_bf16_f32 v79, v182, v183
  v_permlane16_swap_b32 v72, v74
  v_permlane16_swap_b32 v73, v75
  v_permlane16_swap_b32 v76, v78
  v_permlane16_swap_b32 v77, v79
  v_cvt_pk_bf16_f32 v80, v136, v137
  v_cvt_pk_bf16_f32 v81, v138, v139
  v_cvt_pk_bf16_f32 v82, v140, v141
  v_cvt_pk_bf16_f32 v83, v142, v143
  v_cvt_pk_bf16_f32 v84, v152, v153
  v_cvt_pk_bf16_f32 v85, v154, v155
  v_cvt_pk_bf16_f32 v86, v156, v157
  v_cvt_pk_bf16_f32 v87, v158, v159
  v_permlane16_swap_b32 v80, v82
  v_permlane16_swap_b32 v81, v83
  v_permlane16_swap_b32 v84, v86
  v_permlane16_swap_b32 v85, v87
  v_mfma_f32_32x32x16_bf16 v[128:143], v[36:39], v[72:75], 0
  v_mfma_f32_32x32x16_bf16 v[144:159], v[40:43], v[76:79], 0
  s_barrier
  v_cvt_pk_bf16_f32 v88, v168, v169
  v_cvt_pk_bf16_f32 v89, v170, v171
  v_cvt_pk_bf16_f32 v90, v172, v173
  v_cvt_pk_bf16_f32 v91, v174, v175
  v_cvt_pk_bf16_f32 v92, v184, v185
  v_cvt_pk_bf16_f32 v93, v186, v187
  v_cvt_pk_bf16_f32 v94, v188, v189
  v_cvt_pk_bf16_f32 v95, v190, v191
  v_permlane16_swap_b32 v88, v90
  v_permlane16_swap_b32 v89, v91
  v_permlane16_swap_b32 v92, v94
  v_permlane16_swap_b32 v93, v95
  v_exp_f32 v192, v192
  v_exp_f32 v193, v193
  v_exp_f32 v194, v194
  v_exp_f32 v195, v195
  v_exp_f32 v196, v196
  v_exp_f32 v197, v197
  v_exp_f32 v198, v198
  v_exp_f32 v199, v199
  v_exp_f32 v200, v200
  v_exp_f32 v201, v201
  v_exp_f32 v202, v202
  v_exp_f32 v203, v203
  v_exp_f32 v204, v204
  v_exp_f32 v205, v205
  v_exp_f32 v206, v206
  v_exp_f32 v207, v207
  v_exp_f32 v208, v208
  v_exp_f32 v209, v209
  v_exp_f32 v210, v210
  v_exp_f32 v211, v211
  v_exp_f32 v212, v212
  v_exp_f32 v213, v213
  v_exp_f32 v214, v214
  v_exp_f32 v215, v215
  s_barrier
  ds_write_b128 v23, v[80:83] offset:0
  v_exp_f32 v216, v216
  v_exp_f32 v217, v217
  v_exp_f32 v218, v218
  v_exp_f32 v219, v219
  v_exp_f32 v220, v220
  v_exp_f32 v221, v221
  v_exp_f32 v222, v222
  v_exp_f32 v223, v223
  v_add_f32 v112, v192, v193
  v_add_f32 v113, v194, v195
  v_add_f32 v114, v200, v201
  v_add_f32 v115, v202, v203
  v_add_f32 v112, v112, v196
  ds_write_b128 v23, v[84:87] offset:512
  v_add_f32 v114, v114, v204
  v_add_f32 v113, v113, v197
  v_add_f32 v115, v115, v205
  v_add_f32 v112, v112, v198
  v_add_f32 v114, v114, v206
  v_add_f32 v113, v113, v199
  v_add_f32 v115, v115, v207
  v_add_f32 v112, v112, v113
  v_add_f32 v114, v114, v115
  v_add_f32 v116, v208, v209
  v_add_f32 v117, v210, v211
  v_add_f32 v118, v216, v217
  ds_write_b128 v23, v[88:91] offset:1024
  v_add_f32 v119, v218, v219
  v_add_f32 v116, v116, v212
  v_add_f32 v118, v118, v220
  v_add_f32 v117, v117, v213
  v_add_f32 v119, v119, v221
  v_add_f32 v116, v116, v214
  v_add_f32 v118, v118, v222
  v_add_f32 v117, v117, v215
  v_add_f32 v119, v119, v223
  v_add_f32 v116, v116, v117
  v_add_f32 v118, v118, v119
  v_permlane32_swap_b32 v112, v114
  s_nop 0
  v_permlane32_swap_b32 v116, v118
  ds_write_b128 v23, v[92:95] offset:1536
  v_add_f32 v112, v112, v114
  v_add_f32 v116, v116, v118
  v_add_f32 v113, v112, v116
  v_cmp_nge_f32 vcc, 0x5d800000, v113
  v_rcp_f32 v114, v112
  v_rcp_f32 v118, v116
  s_nop 2
  s_cbranch_vccnz L_fb14
L_fb14_r:
  v_mov_b32 v112, v114
  v_mov_b32 v116, v118
  s_nop 0
  v_permlane32_swap_b32 v112, v114
  v_permlane32_swap_b32 v116, v118
  v_mul_f32 v192, v112, v192
  v_mul_f32 v193, v112, v193
  v_mul_f32 v194, v112, v194
  v_mul_f32 v195, v112, v195
  v_mul_f32 v196, v112, v196
  v_mul_f32 v197, v112, v197
  v_mul_f32 v198, v112, v198
  v_mul_f32 v199, v112, v199
  v_cvt_pk_bf16_f32 v192, v192, v193
  v_cvt_pk_bf16_f32 v193, v194, v195
  v_cvt_pk_bf16_f32 v194, v196, v197
  v_cvt_pk_bf16_f32 v195, v198, v199
  ds_write_b128 v22, v[192:195] offset:0
  v_mul_f32 v200, v114, v200
  v_mul_f32 v201, v114, v201
  v_mul_f32 v202, v114, v202
  v_mul_f32 v203, v114, v203
  v_mul_f32 v204, v114, v204
  v_mul_f32 v205, v114, v205
  v_mul_f32 v206, v114, v206
  v_mul_f32 v207, v114, v207
  v_cvt_pk_bf16_f32 v196, v200, v201
  v_cvt_pk_bf16_f32 v197, v202, v203
  v_cvt_pk_bf16_f32 v198, v204, v205
  v_cvt_pk_bf16_f32 v199, v206, v207
  ds_write_b128 v24, v[196:199] offset:0
  v_mul_f32 v208, v116, v208
  v_mul_f32 v209, v116, v209
  v_mul_f32 v210, v116, v210
  v_mul_f32 v211, v116, v211
  v_mul_f32 v212, v116, v212
  v_mul_f32 v213, v116, v213
  v_mul_f32 v214, v116, v214
  v_mul_f32 v215, v116, v215
  v_cvt_pk_bf16_f32 v208, v208, v209
  v_cvt_pk_bf16_f32 v209, v210, v211
  v_cvt_pk_bf16_f32 v210, v212, v213
  v_cvt_pk_bf16_f32 v211, v214, v215
  ds_write_b128 v22, v[208:211] offset:8192
  v_mul_f32 v216, v118, v216
  v_mul_f32 v217, v118, v217
  v_mul_f32 v218, v118, v218
  v_mul_f32 v219, v118, v219
  v_mul_f32 v220, v118, v220
  v_mul_f32 v221, v118, v221
  v_mul_f32 v222, v118, v222
  v_mul_f32 v223, v118, v223
  v_cvt_pk_bf16_f32 v212, v216, v217
  v_cvt_pk_bf16_f32 v213, v218, v219
  v_cvt_pk_bf16_f32 v214, v220, v221
  v_cvt_pk_bf16_f32 v215, v222, v223
  ds_write_b128 v24, v[212:215] offset:8192
  v_exp_f32 v128, v128
  v_exp_f32 v129, v129
  v_exp_f32 v130, v130
  v_exp_f32 v131, v131
  v_exp_f32 v132, v132
  v_exp_f32 v133, v133
  v_exp_f32 v134, v134
  v_exp_f32 v135, v135
  v_exp_f32 v136, v136
  v_exp_f32 v137, v137
  v_exp_f32 v138, v138
  v_exp_f32 v139, v139
  v_exp_f32 v140, v140
  v_exp_f32 v141, v141
  v_exp_f32 v142, v142
  v_exp_f32 v143, v143
  v_exp_f32 v144, v144
  v_exp_f32 v145, v145
  v_exp_f32 v146, v146
  v_exp_f32 v147, v147
  v_exp_f32 v148, v148
  v_exp_f32 v149, v149
  v_exp_f32 v150, v150
  v_exp_f32 v151, v151
  s_mov_b64 exec, s[30:31]
  s_cbranch_execz L_npa
  buffer_load_dword v13, v26, s[36:39], s9 offen sc1
L_npa:
  s_mov_b64 exec, -1
  v_exp_f32 v152, v152
  v_exp_f32 v153, v153
  v_exp_f32 v154, v154
  v_exp_f32 v155, v155
  v_exp_f32 v156, v156
  v_exp_f32 v157, v157
  v_exp_f32 v158, v158
  v_exp_f32 v159, v159
  v_add_f32 v112, v128, v129
  v_add_f32 v113, v130, v131
  v_add_f32 v114, v136, v137
  v_add_f32 v115, v138, v139
  v_add_f32 v112, v112, v132
  v_add_f32 v114, v114, v140
  v_add_f32 v113, v113, v133
  v_add_f32 v115, v115, v141
  v_add_f32 v112, v112, v134
  v_add_f32 v114, v114, v142
  v_add_f32 v113, v113, v135
  v_add_f32 v115, v115, v143
  v_add_f32 v112, v112, v113
  v_add_f32 v114, v114, v115
  v_add_f32 v116, v144, v145
  v_add_f32 v117, v146, v147
  v_add_f32 v118, v152, v153
  v_add_f32 v119, v154, v155
  v_add_f32 v116, v116, v148
  v_add_f32 v118, v118, v156
  v_add_f32 v117, v117, v149
  v_add_f32 v119, v119, v157
  v_add_f32 v116, v116, v150
  v_add_f32 v118, v118, v158
  v_add_f32 v117, v117, v151
  v_add_f32 v119, v119, v159
  v_add_f32 v116, v116, v117
  v_add_f32 v118, v118, v119
  v_permlane32_swap_b32 v112, v114
  s_nop 0
  v_permlane32_swap_b32 v116, v118
  v_add_f32 v112, v112, v114
  v_add_f32 v116, v116, v118
  v_add_f32 v113, v112, v116
  v_cmp_nge_f32 vcc, 0x5d800000, v113
  v_rcp_f32 v114, v112
  v_rcp_f32 v118, v116
  s_nop 2
  s_cbranch_vccnz L_fb15
L_fb15_r:
  v_mov_b32 v112, v114
  v_mov_b32 v116, v118
  s_nop 0
  v_permlane32_swap_b32 v112, v114
  v_permlane32_swap_b32 v116, v118
  s_waitcnt vmcnt(0)
  s_mov_b64 exec, s[30:31]
  v_cmpx_ne_u32 vcc, s56, v13
  s_nop 4
  s_cbranch_execnz L_sp16
L_sp16_ok:
  s_mov_b64 exec, -1
  s_add_u32 s74, s12, 8192
  s_add_u32 m0, s13, 8192
  s_nop 0
  buffer_load_dwordx4 v2, s[36:39], s74 offen offset:0 sc1 lds
  v_mul_f32 v128, v112, v128
  v_mul_f32 v129, v112, v129
  v_mul_f32 v130, v112, v130
  v_mul_f32 v131, v112, v131
  v_mul_f32 v132, v112, v132
  v_mul_f32 v133, v112, v133
  v_mul_f32 v134, v112, v134
  v_mul_f32 v135, v112, v135
  v_cvt_pk_bf16_f32 v128, v128, v129
  buffer_load_dwordx4 v2, s[36:39], s74 offen offset:1024 sc1 lds
  v_cvt_pk_bf16_f32 v129, v130, v131
  v_cvt_pk_bf16_f32 v130, v132, v133
  v_cvt_pk_bf16_f32 v131, v134, v135
  ds_write_b128 v22, v[128:131] offset:2048
  v_mul_f32 v136, v114, v136
  v_mul_f32 v137, v114, v137
  v_mul_f32 v138, v114, v138
  v_mul_f32 v139, v114, v139
  v_mul_f32 v140, v114, v140
  buffer_load_dwordx4 v2, s[36:39], s74 offen offset:2048 sc1 lds
  v_mul_f32 v141, v114, v141
  v_mul_f32 v142, v114, v142
  v_mul_f32 v143, v114, v143
  v_cvt_pk_bf16_f32 v132, v136, v137
  v_cvt_pk_bf16_f32 v133, v138, v139
  v_cvt_pk_bf16_f32 v134, v140, v141
  v_cvt_pk_bf16_f32 v135, v142, v143
  ds_write_b128 v24, v[132:135] offset:2048
  buffer_load_dwordx4 v2, s[36:39], s74 offen offset:3072 sc1 lds
  v_mul_f32 v144, v116, v144
  v_mul_f32 v145, v116, v145
  v_mul_f32 v146, v116, v146
  v_mul_f32 v147, v116, v147
  v_mul_f32 v148, v116, v148
  v_mul_f32 v149, v116, v149
  v_mul_f32 v150, v116, v150
  v_mul_f32 v151, v116, v151
  v_cvt_pk_bf16_f32 v144, v144, v145
  s_add_u32 s74, s12, 4096
  s_add_u32 m0, s13, 4096
  s_nop 0
  buffer_load_dwordx4 v2, s[36:39], s74 offen offset:0 sc1 lds
  v_cvt_pk_bf16_f32 v145, v146, v147
  v_cvt_pk_bf16_f32 v146, v148, v149
  v_cvt_pk_bf16_f32 v147, v150, v151
  ds_write_b128 v22, v[144:147] offset:10240
  v_mul_f32 v152, v118, v152
  v_mul_f32 v153, v118, v153
  v_mul_f32 v154, v118, v154
  v_mul_f32 v155, v118, v155
  v_mul_f32 v156, v118, v156
  buffer_load_dwordx4 v2, s[36:39], s74 offen offset:1024 sc1 lds
  v_mul_f32 v157, v118, v157
  v_mul_f32 v158, v118, v158
  v_mul_f32 v159, v118, v159
  v_cvt_pk_bf16_f32 v148, v152, v153
  v_cvt_pk_bf16_f32 v149, v154, v155
  v_cvt_pk_bf16_f32 v150, v156, v157
  v_cvt_pk_bf16_f32 v151, v158, v159
  ds_write_b128 v24, v[148:151] offset:10240
  s_cmp_eq_u32 s58, 0
  s_mov_b32 s64, -12288
  s_cselect_b32 s64, 12288, s64
  s_add_u32 s64, s64, s13
  v_mov_b32 v4, s64
  v_mov_b32 v8, s13
  s_waitcnt lgkmcnt(0)
  ds_write_b32 v4, v14
  buffer_load_dwordx4 v2, s[36:39], s74 offen offset:2048 sc1 lds
  buffer_load_dwordx4 v2, s[36:39], s74 offen offset:3072 sc1 lds
  ds_read_b32 v5, v8
  s_waitcnt lgkmcnt(0)
  v_cmp_ne_u32 vcc, s56, v5
  s_nop 4
  s_cbranch_vccnz L_lf
L_lf_ok:
  s_mov_b64 exec, s[60:61]
  ds_read_b128 v[224:227], v34 offset:0
  ds_read_b128 v[228:231], v34 offset:512
  ds_read_b128 v[232:235], v34 offset:1024
  ds_read_b128 v[236:239], v34 offset:1536
  ds_read_b128 v[240:243], v34 offset:2048
  ds_read_b128 v[244:247], v34 offset:2560
  ds_read_b128 v[248:251], v34 offset:3072
  ds_read_b128 v[252:255], v34 offset:3584
  s_mov_b64 exec, -1
  ds_read_b64_tr_b16 v[192:193], v33 offset:0
  ds_read_b64_tr_b16 v[194:195], v61 offset:256
  ds_read_b64_tr_b16 v[196:197], v33 offset:1024
  ds_read_b64_tr_b16 v[198:199], v61 offset:1280
  ds_read_b64_tr_b16 v[200:201], v33 offset:2048
  ds_read_b64_tr_b16 v[202:203], v61 offset:2304
  s_waitcnt lgkmcnt(4)
  ds_read_b64_tr_b16 v[204:205], v33 offset:3072
  ds_read_b64_tr_b16 v[206:207], v61 offset:3328
  ds_read_b64_tr_b16 v[208:209], v33 offset:4096
  ds_read_b64_tr_b16 v[210:211], v61 offset:4352
  ds_read_b64_tr_b16 v[212:213], v33 offset:5120
  ds_read_b64_tr_b16 v[214:215], v61 offset:5376
  ds_read_b64_tr_b16 v[216:217], v33 offset:6144
  ds_read_b64_tr_b16 v[218:219], v61 offset:6400
  ds_read_b64_tr_b16 v[220:221], v33 offset:7168
  ds_read_b64_tr_b16 v[222:223], v61 offset:7424
  s_waitcnt lgkmcnt(14)
  v_mfma_f32_32x32x16_bf16 v[128:143], v[192:195], v[224:227], 0
  s_add_u32 s74, s12, 0
  s_add_u32 m0, s13, 0
  s_nop 0
  buffer_load_dwordx4 v2, s[36:39], s74 offen offset:0 sc1 lds
  s_waitcnt lgkmcnt(12)
  v_mfma_f32_32x32x16_bf16 v[128:143], v[196:199], v[228:231], v[128:143]
  buffer_load_dwordx4 v2, s[36:39], s74 offen offset:1024 sc1 lds
  s_waitcnt lgkmcnt(10)
  v_mfma_f32_32x32x16_bf16 v[128:143], v[200:203], v[232:235], v[128:143]
  buffer_load_dwordx4 v2, s[36:39], s74 offen offset:2048 sc1 lds
  s_waitcnt lgkmcnt(8)
  v_mfma_f32_32x32x16_bf16 v[128:143], v[204:207], v[236:239], v[128:143]
  buffer_load_dwordx4 v2, s[36:39], s74 offen offset:3072 sc1 lds
  s_waitcnt lgkmcnt(6)
  v_mfma_f32_32x32x16_bf16 v[128:143], v[208:211], v[240:243], v[128:143]
  s_waitcnt lgkmcnt(4)
  v_mfma_f32_32x32x16_bf16 v[128:143], v[212:215], v[244:247], v[128:143]
  s_waitcnt lgkmcnt(2)
  v_mfma_f32_32x32x16_bf16 v[128:143], v[216:219], v[248:251], v[128:143]
  s_waitcnt lgkmcnt(0)
  v_mfma_f32_32x32x16_bf16 v[128:143], v[220:223], v[252:255], v[128:143]
  s_barrier
  s_nop 10
  v_cvt_pk_bf16_f32 v144, v128, v129
  v_cvt_pk_bf16_f32 v145, v130, v131
  v_cvt_pk_bf16_f32 v146, v132, v133
  v_cvt_pk_bf16_f32 v147, v134, v135
  v_cvt_pk_bf16_f32 v148, v136, v137
  v_cvt_pk_bf16_f32 v149, v138, v139
  v_cvt_pk_bf16_f32 v150, v140, v141
  v_cvt_pk_bf16_f32 v151, v142, v143
  s_mov_b32 exec_lo, 0x1ffff
  s_mov_b32 exec_hi, 0x1ffff
  s_cmp_eq_u32 s62, 0
  s_cbranch_scc1 L_bo17
  buffer_store_dwordx4 v[144:147], v25, s[36:39], s10 offen
  buffer_store_dwordx4 v[148:151], v54, s[36:39], s10 offen offset:256
L_bo17_r:
  s_mov_b64 exec, -1
  s_lshl_b32 s64, s55, 2
  s_add_u32 s64, s64, 113696
  v_lshl_add_u32 v4, v1, 14, s64
  s_waitcnt vmcnt(0)
  s_mov_b64 exec, 1
  s_cmp_eq_u32 s62, 0
  s_cbranch_scc1 L_bo18
  buffer_store_dword v14, v15, s[36:39], s11 offen
L_bo18_r:
  s_mov_b64 exec, -1
  s_mov_b64 exec, 15
  ds_write_b32 v4, v14
  s_mov_b64 exec, -1
  v_cmp_le_u32 s[78:79], 24, v3
  v_mov_b32 v9, 0x3f803f80
  s_mov_b64 exec, 0xffff
  buffer_load_dword v13, v26, s[36:39], s14 offen sc1
  s_waitcnt vmcnt(0)
  v_cmpx_ne_u32 vcc, s56, v13
  s_nop 4
  s_cbranch_execnz L_sp19
L_sp19_ok:
  s_mov_b64 exec, -1
  s_setprio 2
  buffer_load_dwordx4 v[80:83], v55, s[36:39], s15 offen sc1
  s_add_u32 s75, s15, 0
  buffer_load_dwordx4 v[128:131], v2, s[36:39], s75 offen offset:0 sc1
  buffer_load_dwordx4 v[132:135], v2, s[36:39], s75 offen offset:1024 sc1
  buffer_load_dwordx4 v[136:139], v2, s[36:39], s75 offen offset:2048 sc1
  buffer_load_dwordx4 v[140:143], v2, s[36:39], s75 offen offset:3072 sc1
  s_add_u32 s75, s15, 4096
  buffer_load_dwordx4 v[144:147], v2, s[36:39], s75 offen offset:0 sc1
  buffer_load_dwordx4 v[148:151], v2, s[36:39], s75 offen offset:1024 sc1
  buffer_load_dwordx4 v[152:155], v2, s[36:39], s75 offen offset:2048 sc1
  s_waitcnt vmcnt(6)
  v_mfma_f32_32x32x16_bf16 v[96:111], v[44:47], v[128:131], 0
  v_lshlrev_b32 v84, 16, v80
  v_and_b32 v85, 0xffff0000, v80
  v_lshlrev_b32 v86, 16, v81
  v_and_b32 v87, 0xffff0000, v81
  v_lshlrev_b32 v88, 16, v82
  buffer_load_dwordx4 v[156:159], v2, s[36:39], s75 offen offset:3072 sc1
  s_waitcnt vmcnt(6)
  v_mfma_f32_32x32x16_bf16 v[96:111], v[44:47], v[132:135], v[96:111]
  v_and_b32 v89, 0xffff0000, v82
  v_lshlrev_b32 v90, 16, v83
  v_and_b32 v91, 0xffff0000, v83
  v_add_f32_dpp v84, v84, v84 quad_perm:[1,0,3,2] row_mask:0xf bank_mask:0xf
  v_add_f32_dpp v85, v85, v85 quad_perm:[1,0,3,2] row_mask:0xf bank_mask:0xf
  s_add_u32 s75, s15, 8192
  buffer_load_dwordx4 v[160:163], v2, s[36:39], s75 offen offset:0 sc1
  s_waitcnt vmcnt(6)
  v_mfma_f32_32x32x16_bf16 v[96:111], v[44:47], v[136:139], v[96:111]
  v_add_f32_dpp v86, v86, v86 quad_perm:[1,0,3,2] row_mask:0xf bank_mask:0xf
  v_add_f32_dpp v87, v87, v87 quad_perm:[1,0,3,2] row_mask:0xf bank_mask:0xf
  v_add_f32_dpp v88, v88, v88 quad_perm:[1,0,3,2] row_mask:0xf bank_mask:0xf
  v_add_f32_dpp v89, v89, v89 quad_perm:[1,0,3,2] row_mask:0xf bank_mask:0xf
  v_add_f32_dpp v90, v90, v90 quad_perm:[1,0,3,2] row_mask:0xf bank_mask:0xf
  buffer_load_dwordx4 v[164:167], v2, s[36:39], s75 offen offset:1024 sc1
  s_waitcnt vmcnt(6)
  v_mfma_f32_32x32x16_bf16 v[96:111], v[44:47], v[140:143], v[96:111]
  v_add_f32_dpp v91, v91, v91 quad_perm:[1,0,3,2] row_mask:0xf bank_mask:0xf
  v_add_f32_dpp v84, v84, v84 quad_perm:[2,3,0,1] row_mask:0xf bank_mask:0xf
  v_add_f32_dpp v85, v85, v85 quad_perm:[2,3,0,1] row_mask:0xf bank_mask:0xf
  v_add_f32_dpp v86, v86, v86 quad_perm:[2,3,0,1] row_mask:0xf bank_mask:0xf
  v_add_f32_dpp v87, v87, v87 quad_perm:[2,3,0,1] row_mask:0xf bank_mask:0xf
  buffer_load_dwordx4 v[168:171], v2, s[36:39], s75 offen offset:2048 sc1
  s_waitcnt vmcnt(6)
  v_mfma_f32_32x32x16_bf16 v[96:111], v[44:47], v[144:147], v[96:111]
  v_add_f32_dpp v88, v88, v88 quad_perm:[2,3,0,1] row_mask:0xf bank_mask:0xf
  v_add_f32_dpp v89, v89, v89 quad_perm:[2,3,0,1] row_mask:0xf bank_mask:0xf
  v_add_f32_dpp v90, v90, v90 quad_perm:[2,3,0,1] row_mask:0xf bank_mask:0xf
  v_add_f32_dpp v91, v91, v91 quad_perm:[2,3,0,1] row_mask:0xf bank_mask:0xf
  v_add_f32_dpp v84, v84, v84 row_half_mirror row_mask:0xf bank_mask:0xf
  buffer_load_dwordx4 v[172:175], v2, s[36:39], s75 offen offset:3072 sc1
  s_waitcnt vmcnt(6)
  v_mfma_f32_32x32x16_bf16 v[96:111], v[44:47], v[148:151], v[96:111]
  v_add_f32_dpp v85, v85, v85 row_half_mirror row_mask:0xf bank_mask:0xf
  v_add_f32_dpp v86, v86, v86 row_half_mirror row_mask:0xf bank_mask:0xf
  v_add_f32_dpp v87, v87, v87 row_half_mirror row_mask:0xf bank_mask:0xf
  v_add_f32_dpp v88, v88, v88 row_half_mirror row_mask:0xf bank_mask:0xf
  v_add_f32_dpp v89, v89, v89 row_half_mirror row_mask:0xf bank_mask:0xf
  s_add_u32 s75, s15, 12288
  buffer_load_dwordx4 v[176:179], v2, s[36:39], s75 offen offset:0 sc1
  s_waitcnt vmcnt(6)
  v_mfma_f32_32x32x16_bf16 v[96:111], v[44:47], v[152:155], v[96:111]
  v_add_f32_dpp v90, v90, v90 row_half_mirror row_mask:0xf bank_mask:0xf
  v_add_f32_dpp v91, v91, v91 row_half_mirror row_mask:0xf bank_mask:0xf
  v_add_f32_dpp v84, v84, v84 row_mirror row_mask:0xf bank_mask:0xf
  v_add_f32_dpp v85, v85, v85 row_mirror row_mask:0xf bank_mask:0xf
  v_add_f32_dpp v86, v86, v86 row_mirror row_mask:0xf bank_mask:0xf
  buffer_load_dwordx4 v[180:183], v2, s[36:39], s75 offen offset:1024 sc1
  s_waitcnt vmcnt(6)
  v_mfma_f32_32x32x16_bf16 v[96:111], v[44:47], v[156:159], v[96:111]
  v_add_f32_dpp v87, v87, v87 row_mirror row_mask:0xf bank_mask:0xf
  v_add_f32_dpp v88, v88, v88 row_mirror row_mask:0xf bank_mask:0xf
  v_add_f32_dpp v89, v89, v89 row_mirror row_mask:0xf bank_mask:0xf
  v_add_f32_dpp v90, v90, v90 row_mirror row_mask:0xf bank_mask:0xf
  v_add_f32_dpp v91, v91, v91 row_mirror row_mask:0xf bank_mask:0xf
  buffer_load_dwordx4 v[184:187], v2, s[36:39], s75 offen offset:2048 sc1
  s_waitcnt vmcnt(6)
  v_mfma_f32_32x32x16_bf16 v[96:111], v[44:47], v[160:163], v[96:111]
  v_cvt_pk_bf16_f32 v116, v84, v85
  v_cvt_pk_bf16_f32 v117, v86, v87
  v_cvt_pk_bf16_f32 v118, v88, v89
  v_cvt_pk_bf16_f32 v119, v90, v91
  buffer_load_dwordx4 v[188:191], v2, s[36:39], s75 offen offset:3072 sc1
  s_waitcnt vmcnt(6)
  v_mfma_f32_32x32x16_bf16 v[96:111], v[44:47], v[164:167], v[96:111]
  v_and_b32 v4, 7, v1
  v_lshl_add_u32 v4, v4, 2, s33
  ds_read_b32 v5, v4 offset:15376
  s_waitcnt lgkmcnt(0)
  v_cmp_ne_u32 vcc, s56, v5
  s_nop 4
  s_cbranch_vccnz L_le
L_le_ok:
  ds_read_b128 v[192:195], v32 offset:0
  ds_read_b128 v[196:199], v32 offset:1024
  ds_read_b128 v[200:203], v32 offset:2048
  ds_read_b128 v[204:207], v32 offset:3072
  ds_read_b128 v[208:211], v32 offset:4096
  ds_read_b128 v[212:215], v32 offset:5120
  ds_read_b128 v[216:219], v32 offset:6144
  ds_read_b128 v[220:223], v32 offset:7168
  s_add_u32 m0, s33, 8192
  s_add_u32 s80, s32, 65536
  buffer_load_dwordx4 v27, s[40:43], s80 offen lds
  s_waitcnt vmcnt(6)
  v_mfma_f32_32x32x16_bf16 v[96:111], v[44:47], v[168:171], v[96:111]
  s_waitcnt vmcnt(5)
  v_mfma_f32_32x32x16_bf16 v[96:111], v[44:47], v[172:175], v[96:111]
  s_add_u32 m0, s33, 9216
  s_add_u32 s80, s32, 73728
  buffer_load_dwordx4 v27, s[40:43], s80 offen lds
  s_waitcnt vmcnt(5)
  v_mfma_f32_32x32x16_bf16 v[96:111], v[44:47], v[176:179], v[96:111]
  s_waitcnt vmcnt(4)
  v_mfma_f32_32x32x16_bf16 v[96:111], v[44:47], v[180:183], v[96:111]
  s_add_u32 m0, s33, 10240
  s_add_u32 s80, s32, 81920
  buffer_load_dwordx4 v27, s[40:43], s80 offen lds
  s_waitcnt vmcnt(4)
  v_mfma_f32_32x32x16_bf16 v[96:111], v[44:47], v[184:187], v[96:111]
  s_waitcnt vmcnt(3)
  v_mfma_f32_32x32x16_bf16 v[96:111], v[44:47], v[188:191], v[96:111]
  s_waitcnt lgkmcnt(0)
  s_add_u32 m0, s33, 11264
  s_add_u32 s80, s32, 90112
  buffer_load_dwordx4 v27, s[40:43], s80 offen lds
  s_nop 7
  v_cvt_pk_bf16_f32 v112, v96, v97
  v_cvt_pk_bf16_f32 v113, v98, v99
  v_cvt_pk_bf16_f32 v114, v100, v101
  v_cvt_pk_bf16_f32 v115, v102, v103
  v_permlane16_swap_b32 v112, v116
  v_permlane16_swap_b32 v113, v117
  v_permlane16_swap_b32 v114, v118
  v_permlane16_swap_b32 v115, v119
  v_cndmask_b32_e64 v112, v112, v9, s[78:79]
  v_cndmask_b32_e64 v113, v113, v9, s[78:79]
  v_cndmask_b32_e64 v114, v114, v9, s[78:79]
  v_cndmask_b32_e64 v115, v115, v9, s[78:79]
  v_cndmask_b32_e64 v116, v116, v9, s[78:79]
  v_cndmask_b32_e64 v117, v117, v9, s[78:79]
  v_cndmask_b32_e64 v118, v118, v9, s[78:79]
  v_cndmask_b32_e64 v119, v119, v9, s[78:79]
  s_waitcnt lgkmcnt(0)
  v_mfma_f32_32x32x16_bf16 v[128:143], v[112:115], v[192:195], 0
  v_mfma_f32_32x32x16_bf16 v[144:159], v[116:119], v[196:199], 0
  v_mfma_f32_32x32x16_bf16 v[160:175], v[112:115], v[200:203], 0
  v_mfma_f32_32x32x16_bf16 v[176:191], v[116:119], v[204:207], 0
  s_add_u32 m0, s33, 12288
  s_add_u32 s80, s32, 98304
  buffer_load_dwordx4 v27, s[40:43], s80 offen lds
  v_mfma_f32_32x32x16_bf16 v[64:79], v[112:115], v[208:211], 0
  v_mfma_f32_32x32x16_bf16 v[80:95], v[116:119], v[212:215], 0
  v_mfma_f32_32x32x16_bf16 v[224:239], v[112:115], v[216:219], 0
  v_mfma_f32_32x32x16_bf16 v[240:255], v[116:119], v[220:223], 0
  s_add_u32 m0, s33, 13312
  s_add_u32 s80, s32, 106496
  buffer_load_dwordx4 v27, s[40:43], s80 offen lds
  v_rcp_f32 v8, v140
  v_rcp_f32 v10, v156
  s_add_u32 s75, s16, 0
  v_mul_f32 v6, v136, v8
  v_fmac_f32 v6, v152, v10
  v_add_f32 v6, 0x358637bd, v6
  v_rcp_f32 v6, v6
  s_nop 0
  v_mul_f32 v8, v8, v6
  v_mul_f32 v10, v10, v6
  v_mul_f32 v128, v8, v128
  v_mul_f32 v129, v8, v129
  v_mul_f32 v130, v8, v130
  v_mul_f32 v131, v8, v131
  v_mul_f32 v132, v8, v132
  v_mul_f32 v133, v8, v133
  v_mul_f32 v134, v8, v134
  v_mul_f32 v135, v8, v135
  v_fmac_f32 v128, v10, v144
  v_fmac_f32 v129, v10, v145
  v_fmac_f32 v130, v10, v146
  v_fmac_f32 v131, v10, v147
  v_fmac_f32 v132, v10, v148
  v_fmac_f32 v133, v10, v149
  v_fmac_f32 v134, v10, v150
  v_fmac_f32 v135, v10, v151
  v_cvt_pk_bf16_f32 v136, v128, v129
  v_cvt_pk_bf16_f32 v137, v130, v131
  v_cvt_pk_bf16_f32 v138, v132, v133
  v_cvt_pk_bf16_f32 v139, v134, v135
  buffer_store_dwordx4 v[136:139], v2, s[36:39], s75 offen sc1
  s_add_u32 m0, s33, 14336
  s_add_u32 s80, s32, 114688
  buffer_load_dwordx4 v27, s[40:43], s80 offen lds
  v_rcp_f32 v8, v172
  v_rcp_f32 v10, v188
  s_add_u32 s75, s16, 65536
  v_mul_f32 v6, v168, v8
  v_fmac_f32 v6, v184, v10
  v_add_f32 v6, 0x358637bd, v6
  v_rcp_f32 v6, v6
  s_nop 0
  v_mul_f32 v8, v8, v6
  v_mul_f32 v10, v10, v6
  v_mul_f32 v160, v8, v160
  v_mul_f32 v161, v8, v161
  v_mul_f32 v162, v8, v162
  v_mul_f32 v163, v8, v163
  v_mul_f32 v164, v8, v164
  v_mul_f32 v165, v8, v165
  v_mul_f32 v166, v8, v166
  v_mul_f32 v167, v8, v167
  v_fmac_f32 v160, v10, v176
  v_fmac_f32 v161, v10, v177
  v_fmac_f32 v162, v10, v178
  v_fmac_f32 v163, v10, v179
  v_fmac_f32 v164, v10, v180
  v_fmac_f32 v165, v10, v181
  v_fmac_f32 v166, v10, v182
  v_fmac_f32 v167, v10, v183
  v_cvt_pk_bf16_f32 v168, v160, v161
  v_cvt_pk_bf16_f32 v169, v162, v163
  v_cvt_pk_bf16_f32 v170, v164, v165
  v_cvt_pk_bf16_f32 v171, v166, v167
  buffer_store_dwordx4 v[168:171], v2, s[36:39], s75 offen sc1
  s_add_u32 m0, s33, 0
  s_add_u32 s80, s32, 0
  buffer_load_dwordx4 v27, s[40:43], s80 offen lds
  v_rcp_f32 v8, v76
  v_rcp_f32 v10, v92
  s_add_u32 s75, s16, 131072
  v_mul_f32 v6, v72, v8
  v_fmac_f32 v6, v88, v10
  v_add_f32 v6, 0x358637bd, v6
  v_rcp_f32 v6, v6
  s_nop 0
  v_mul_f32 v8, v8, v6
  v_mul_f32 v10, v10, v6
  v_mul_f32 v64, v8, v64
  v_mul_f32 v65, v8, v65
  v_mul_f32 v66, v8, v66
  v_mul_f32 v67, v8, v67
  v_mul_f32 v68, v8, v68
  v_mul_f32 v69, v8, v69
  v_mul_f32 v70, v8, v70
  v_mul_f32 v71, v8, v71
  v_fmac_f32 v64, v10, v80
  v_fmac_f32 v65, v10, v81
  v_fmac_f32 v66, v10, v82
  v_fmac_f32 v67, v10, v83
  v_fmac_f32 v68, v10, v84
  v_fmac_f32 v69, v10, v85
  v_fmac_f32 v70, v10, v86
  v_fmac_f32 v71, v10, v87
  v_cvt_pk_bf16_f32 v72, v64, v65
  v_cvt_pk_bf16_f32 v73, v66, v67
  v_cvt_pk_bf16_f32 v74, v68, v69
  v_cvt_pk_bf16_f32 v75, v70, v71
  buffer_store_dwordx4 v[72:75], v2, s[36:39], s75 offen sc1
  s_add_u32 m0, s33, 1024
  s_add_u32 s80, s32, 8192
  buffer_load_dwordx4 v27, s[40:43], s80 offen lds
  v_rcp_f32 v8, v236
  v_rcp_f32 v10, v252
  s_add_u32 s75, s16, 196608
  v_mul_f32 v6, v232, v8
  v_fmac_f32 v6, v248, v10
  v_add_f32 v6, 0x358637bd, v6
  v_rcp_f32 v6, v6
  s_nop 0
  v_mul_f32 v8, v8, v6
  v_mul_f32 v10, v10, v6
  v_mul_f32 v224, v8, v224
  v_mul_f32 v225, v8, v225
  v_mul_f32 v226, v8, v226
  v_mul_f32 v227, v8, v227
  v_mul_f32 v228, v8, v228
  v_mul_f32 v229, v8, v229
  v_mul_f32 v230, v8, v230
  v_mul_f32 v231, v8, v231
  v_fmac_f32 v224, v10, v240
  v_fmac_f32 v225, v10, v241
  v_fmac_f32 v226, v10, v242
  v_fmac_f32 v227, v10, v243
  v_fmac_f32 v228, v10, v244
  v_fmac_f32 v229, v10, v245
  v_fmac_f32 v230, v10, v246
  v_fmac_f32 v231, v10, v247
  v_cvt_pk_bf16_f32 v232, v224, v225
  v_cvt_pk_bf16_f32 v233, v226, v227
  v_cvt_pk_bf16_f32 v234, v228, v229
  v_cvt_pk_bf16_f32 v235, v230, v231
  buffer_store_dwordx4 v[232:235], v2, s[36:39], s75 offen sc1
  s_setprio 0
  v_bfe_u32 v4, v1, 4, 1
  s_and_b32 s77, s25, 24576
  s_andn2_b32 s25, s25, 0x6000
  s_add_u32 s77, s77, 4096
  v_mul_u32_u24 v4, s77, v4
  v_add_u32 v11, v4, v26
  buffer_load_dwordx2 v[6:7], v0, s[36:39], s26 offen sc1
  s_add_u32 m0, s33, 2048
  s_add_u32 s80, s32, 16384
  buffer_load_dwordx4 v27, s[40:43], s80 offen lds
  s_add_u32 m0, s33, 3072
  s_add_u32 s80, s32, 24576
  buffer_load_dwordx4 v27, s[40:43], s80 offen lds
  s_add_u32 m0, s33, 4096
  s_add_u32 s80, s32, 32768
  buffer_load_dwordx4 v27, s[40:43], s80 offen lds
  s_add_u32 m0, s33, 5120
  s_add_u32 s80, s32, 40960
  buffer_load_dwordx4 v27, s[40:43], s80 offen lds
  s_add_u32 m0, s33, 6144
  s_add_u32 s80, s32, 49152
  buffer_load_dwordx4 v27, s[40:43], s80 offen lds
  s_add_u32 m0, s33, 7168
  s_add_u32 s80, s32, 57344
  buffer_load_dwordx4 v27, s[40:43], s80 offen lds
  v_and_b32 v8, 3, v1
  v_lshlrev_b32 v8, 2, v8
  s_lshl_b32 s64, s55, 2
  s_add_u32 s64, s64, 73728
  s_and_b32 s65, s56, 0x3fff3fff
  v_mov_b32 v4, s64
  v_mov_b32 v9, s65
  v_add_u32 v10, 73728, v8
  s_waitcnt vmcnt(7)
  ds_write_b32 v4, v9
  ds_read_b32 v5, v10
  s_waitcnt lgkmcnt(0)
  v_cmp_ne_u32 vcc, v9, v5
  s_nop 4
  s_cbranch_vccnz L_nofa
  s_mov_b64 exec, 1
  buffer_store_dword v14, v15, s[36:39], s17 offen sc1
  s_mov_b64 exec, -1
L_nofa:
  s_add_u32 m0, s35, 0
  s_add_u32 s80, s34, 0
  buffer_load_dwordx4 v27, s[44:47], s80 offen lds
  s_add_u32 m0, s35, 1024
  s_add_u32 s80, s34, 8192
  buffer_load_dwordx4 v27, s[44:47], s80 offen lds
  s_add_u32 m0, s35, 2048
  s_add_u32 s80, s34, 16384
  buffer_load_dwordx4 v27, s[44:47], s80 offen lds
  s_add_u32 m0, s35, 3072
  s_add_u32 s80, s34, 24576
  buffer_load_dwordx4 v27, s[44:47], s80 offen lds
  s_add_u32 m0, s35, 4096
  s_add_u32 s80, s34, 32768
  buffer_load_dwordx4 v27, s[44:47], s80 offen lds
  s_add_u32 m0, s35, 5120
  s_add_u32 s80, s34, 40960
  buffer_load_dwordx4 v27, s[44:47], s80 offen lds
  s_add_u32 m0, s35, 6144
  s_add_u32 s80, s34, 49152
  buffer_load_dwordx4 v27, s[44:47], s80 offen lds
  s_add_u32 m0, s35, 7168
  s_add_u32 s80, s34, 57344
  buffer_load_dwordx4 v27, s[44:47], s80 offen lds
  s_add_u32 m0, s35, 8192
  s_add_u32 s80, s34, 65536
  buffer_load_dwordx4 v27, s[44:47], s80 offen lds
  s_add_u32 m0, s35, 9216
  s_add_u32 s80, s34, 73728
  buffer_load_dwordx4 v27, s[44:47], s80 offen lds
  s_add_u32 m0, s35, 10240
  s_add_u32 s80, s34, 81920
  buffer_load_dwordx4 v27, s[44:47], s80 offen lds
  s_add_u32 m0, s35, 11264
  s_add_u32 s80, s34, 90112
  buffer_load_dwordx4 v27, s[44:47], s80 offen lds
L_tail:
  v_lshlrev_b32 v63, 3, v11
  s_mov_b32 exec_lo, 0x55551111
  s_mov_b32 exec_hi, 0
  buffer_load_dword v13, v11, s[36:39], s25 offen sc1
  s_mov_b64 exec, -1
  v_and_b32 v4, 3, v1
  v_lshl_add_u32 v4, v4, 2, s33
  ds_read_b32 v5, v4 offset:15360
  s_waitcnt lgkmcnt(0)
  v_cmp_ne_u32 vcc, s56, v5
  s_nop 4
  s_cbranch_vccnz L_lp
L_lp_ok:
  s_add_u32 m0, s33, 15360
  s_add_u32 s80, s32, 122880
  buffer_load_dwordx4 v27, s[40:43], s80 offen lds
  s_add_u32 m0, s29, 0
  s_add_u32 s80, s28, 0
  buffer_load_dwordx4 v27, s[44:47], s80 offen lds
  s_add_u32 m0, s29, 1024
  s_add_u32 s80, s28, 8192
  buffer_load_dwordx4 v27, s[44:47], s80 offen lds
  s_add_u32 m0, s29, 2048
  s_add_u32 s80, s28, 16384
  buffer_load_dwordx4 v27, s[44:47], s80 offen lds
  s_add_u32 m0, s29, 3072
  s_add_u32 s80, s28, 24576
  buffer_load_dwordx4 v27, s[44:47], s80 offen lds
  s_lshl_b32 s64, s55, 2
  s_add_u32 s64, s64, 63488
  s_xor_b32 s65, s64, 4
  v_mov_b32 v62, s64
  v_mov_b32 v10, s65
  v_xor_b32 v8, 64, v28
  v_xor_b32 v9, 64, v29
  v_add_u32 v60, 40960, v29
  v_add_u32 v61, 40960, v9
  s_add_u32 s68, s24, 0
  s_add_u32 s69, s24, 4096
  s_add_u32 s70, s24, 8192
  s_add_u32 s71, s24, 12288
  s_add_u32 s72, s24, 32768
  s_add_u32 s73, s24, 36864
  s_add_u32 s74, s24, 40960
  s_add_u32 s75, s24, 45056
  s_waitcnt vmcnt(5)
  v_cmp_ne_u32 vcc, s56, v13
  s_nop 3
  s_and_b32 s76, vcc_lo, 0x55551111
  s_and_b32 s77, s76, 0x1111
  s_cbranch_scc1 L_ta
L_ta_ok:
  s_and_b32 s77, s76, 0x11110000
  s_cselect_b64 s[78:79], 1, -1
  buffer_load_dwordx4 v[128:131], v2, s[36:39], s68 offen offset:0 sc1
  buffer_load_dwordx4 v[132:135], v2, s[36:39], s68 offen offset:1024 sc1
  buffer_load_dwordx4 v[136:139], v2, s[36:39], s68 offen offset:2048 sc1
  buffer_load_dwordx4 v[140:143], v2, s[36:39], s68 offen offset:3072 sc1
  buffer_load_dwordx4 v[144:147], v2, s[36:39], s69 offen offset:0 sc1
  buffer_load_dwordx4 v[148:151], v2, s[36:39], s69 offen offset:1024 sc1
  s_waitcnt vmcnt(6)
  ds_write_b32 v62, v14
  buffer_load_dwordx4 v[152:155], v2, s[36:39], s69 offen offset:2048 sc1
  buffer_load_dwordx4 v[156:159], v2, s[36:39], s69 offen offset:3072 sc1
  buffer_load_dwordx4 v[160:163], v2, s[36:39], s70 offen offset:0 sc1
  buffer_load_dwordx4 v[164:167], v2, s[36:39], s70 offen offset:1024 sc1
  buffer_load_dwordx4 v[168:171], v2, s[36:39], s70 offen offset:2048 sc1
  buffer_load_dwordx4 v[172:175], v2, s[36:39], s70 offen offset:3072 sc1
  s_mov_b32 exec_lo, 0x44440000
  s_mov_b32 exec_hi, 0
  buffer_load_dword v13, v11, s[36:39], s25 offen sc1
  s_mov_b64 exec, -1
  ds_read_b32 v5, v10
  s_waitcnt lgkmcnt(0)
  v_cmp_ne_u32 vcc, s56, v5
  s_nop 4
  s_cbranch_vccnz L_lg
L_lg_ok:
  ds_read_b64_tr_b16 v[192:193], v28 offset:0
  ds_read_b64_tr_b16 v[194:195], v28 offset:1024
  ds_read_b64_tr_b16 v[196:197], v8 offset:0
  ds_read_b64_tr_b16 v[198:199], v8 offset:1024
  ds_read_b64_tr_b16 v[200:201], v28 offset:2048
  ds_read_b64_tr_b16 v[202:203], v28 offset:3072
  ds_read_b64_tr_b16 v[204:205], v8 offset:2048
  ds_read_b64_tr_b16 v[206:207], v8 offset:3072
  ds_read_b64_tr_b16 v[208:209], v28 offset:4096
  ds_read_b64_tr_b16 v[210:211], v28 offset:5120
  ds_read_b64_tr_b16 v[212:213], v8 offset:4096
  ds_read_b64_tr_b16 v[214:215], v8 offset:5120
  s_waitcnt vmcnt(12) lgkmcnt(8)
  v_mfma_f32_32x32x16_bf16 v[64:79], v[192:195], v[128:131], 0
  ds_read_b64_tr_b16 v[216:217], v28 offset:6144
  ds_read_b64_tr_b16 v[218:219], v28 offset:7168
  ds_read_b64_tr_b16 v[220:221], v8 offset:6144
  ds_read_b64_tr_b16 v[222:223], v8 offset:7168
  v_mfma_f32_32x32x16_bf16 v[80:95], v[196:199], v[128:131], 0
  buffer_load_dwordx4 v[176:179], v2, s[36:39], s71 offen offset:0 sc1
  s_waitcnt vmcnt(12) lgkmcnt(8)
  v_mfma_f32_32x32x16_bf16 v[64:79], v[200:203], v[132:135], v[64:79]
  ds_read_b64_tr_b16 v[224:225], v28 offset:8192
  ds_read_b64_tr_b16 v[226:227], v28 offset:9216
  ds_read_b64_tr_b16 v[228:229], v8 offset:8192
  ds_read_b64_tr_b16 v[230:231], v8 offset:9216
  v_mfma_f32_32x32x16_bf16 v[80:95], v[204:207], v[132:135], v[80:95]
  buffer_load_dwordx4 v[180:183], v2, s[36:39], s71 offen offset:1024 sc1
  s_waitcnt vmcnt(12) lgkmcnt(8)
  v_mfma_f32_32x32x16_bf16 v[64:79], v[208:211], v[136:139], v[64:79]
  ds_read_b64_tr_b16 v[232:233], v28 offset:10240
  ds_read_b64_tr_b16 v[234:235], v28 offset:11264
  ds_read_b64_tr_b16 v[236:237], v8 offset:10240
  ds_read_b64_tr_b16 v[238:239], v8 offset:11264
  v_mfma_f32_32x32x16_bf16 v[80:95], v[212:215], v[136:139], v[80:95]
  buffer_load_dwordx4 v[184:187], v2, s[36:39], s71 offen offset:2048 sc1
  s_waitcnt vmcnt(12) lgkmcnt(8)
  v_mfma_f32_32x32x16_bf16 v[64:79], v[216:219], v[140:143], v[64:79]
  ds_read_b64_tr_b16 v[240:241], v28 offset:12288
  ds_read_b64_tr_b16 v[242:243], v28 offset:13312
  ds_read_b64_tr_b16 v[244:245], v8 offset:12288
  ds_read_b64_tr_b16 v[246:247], v8 offset:13312
  v_mfma_f32_32x32x16_bf16 v[80:95], v[220:223], v[140:143], v[80:95]
  buffer_load_dwordx4 v[188:191], v2, s[36:39], s71 offen offset:3072 sc1
  s_waitcnt vmcnt(12) lgkmcnt(8)
  v_mfma_f32_32x32x16_bf16 v[64:79], v[224:227], v[144:147], v[64:79]
  ds_read_b64_tr_b16 v[248:249], v28 offset:14336
  ds_read_b64_tr_b16 v[250:251], v28 offset:15360
  ds_read_b64_tr_b16 v[252:253], v8 offset:14336
  ds_read_b64_tr_b16 v[254:255], v8 offset:15360
  v_mfma_f32_32x32x16_bf16 v[80:95], v[228:231], v[144:147], v[80:95]
  s_mov_b64 exec, s[78:79]
  buffer_load_dwordx4 v[128:131], v2, s[36:39], s72 offen offset:0 sc1
  s_mov_b64 exec, -1
  s_waitcnt vmcnt(12) lgkmcnt(8)
  v_mfma_f32_32x32x16_bf16 v[64:79], v[232:235], v[148:151], v[64:79]
  ds_read_b64_tr_b16 v[192:193], v28 offset:16384
  ds_read_b64_tr_b16 v[194:195], v28 offset:17408
  ds_read_b64_tr_b16 v[196:197], v8 offset:16384
  ds_read_b64_tr_b16 v[198:199], v8 offset:17408
  v_mfma_f32_32x32x16_bf16 v[80:95], v[236:239], v[148:151], v[80:95]
  s_mov_b64 exec, s[78:79]
  buffer_load_dwordx4 v[132:135], v2, s[36:39], s72 offen offset:1024 sc1
  s_mov_b64 exec, -1
  s_waitcnt vmcnt(12) lgkmcnt(8)
  v_mfma_f32_32x32x16_bf16 v[64:79], v[240:243], v[152:155], v[64:79]
  ds_read_b64_tr_b16 v[200:201], v28 offset:18432
  ds_read_b64_tr_b16 v[202:203], v28 offset:19456
  ds_read_b64_tr_b16 v[204:205], v8 offset:18432
  ds_read_b64_tr_b16 v[206:207], v8 offset:19456
  v_mfma_f32_32x32x16_bf16 v[80:95], v[244:247], v[152:155], v[80:95]
  s_mov_b64 exec, s[78:79]
  buffer_load_dwordx4 v[136:139], v2, s[36:39], s73 offen offset:0 sc1
  s_mov_b64 exec, -1
  s_waitcnt vmcnt(12) lgkmcnt(8)
  v_mfma_f32_32x32x16_bf16 v[64:79], v[248:251], v[156:159], v[64:79]
  ds_read_b64_tr_b16 v[208:209], v28 offset:20480
  ds_read_b64_tr_b16 v[210:211], v28 offset:21504
  ds_read_b64_tr_b16 v[212:213], v8 offset:20480
  ds_read_b64_tr_b16 v[214:215], v8 offset:21504
  v_mfma_f32_32x32x16_bf16 v[80:95], v[252:255], v[156:159], v[80:95]
  s_mov_b64 exec, s[78:79]
  buffer_load_dwordx4 v[140:143], v2, s[36:39], s73 offen offset:1024 sc1
  s_mov_b64 exec, -1
  s_waitcnt vmcnt(12) lgkmcnt(8)
  v_mfma_f32_32x32x16_bf16 v[64:79], v[192:195], v[160:163], v[64:79]
  ds_read_b64_tr_b16 v[216:217], v28 offset:22528
  ds_read_b64_tr_b16 v[218:219], v28 offset:23552
  ds_read_b64_tr_b16 v[220:221], v8 offset:22528
  ds_read_b64_tr_b16 v[222:223], v8 offset:23552
  v_mfma_f32_32x32x16_bf16 v[80:95], v[196:199], v[160:163], v[80:95]
  s_mov_b64 exec, s[78:79]
  buffer_load_dwordx4 v[144:147], v2, s[36:39], s74 offen offset:0 sc1
  s_mov_b64 exec, -1
  s_waitcnt vmcnt(12) lgkmcnt(8)
  v_mfma_f32_32x32x16_bf16 v[64:79], v[200:203], v[164:167], v[64:79]
  ds_read_b64_tr_b16 v[224:225], v28 offset:24576
  ds_read_b64_tr_b16 v[226:227], v28 offset:25600
  ds_read_b64_tr_b16 v[228:229], v8 offset:24576
  ds_read_b64_tr_b16 v[230:231], v8 offset:25600
  v_mfma_f32_32x32x16_bf16 v[80:95], v[204:207], v[164:167], v[80:95]
  s_mov_b64 exec, s[78:79]
  buffer_load_dwordx4 v[148:151], v2, s[36:39], s74 offen offset:1024 sc1
  s_mov_b64 exec, -1
  s_waitcnt vmcnt(12) lgkmcnt(8)
  v_mfma_f32_32x32x16_bf16 v[64:79], v[208:211], v[168:171], v[64:79]
  ds_read_b64_tr_b16 v[232:233], v28 offset:26624
  ds_read_b64_tr_b16 v[234:235], v28 offset:27648
  ds_read_b64_tr_b16 v[236:237], v8 offset:26624
  ds_read_b64_tr_b16 v[238:239], v8 offset:27648
  v_mfma_f32_32x32x16_bf16 v[80:95], v[212:215], v[168:171], v[80:95]
  s_mov_b64 exec, s[78:79]
  buffer_load_dwordx4 v[152:155], v2, s[36:39], s75 offen offset:0 sc1
  s_mov_b64 exec, -1
  s_waitcnt vmcnt(12) lgkmcnt(8)
  v_mfma_f32_32x32x16_bf16 v[64:79], v[216:219], v[172:175], v[64:79]
  ds_read_b64_tr_b16 v[240:241], v28 offset:28672
  ds_read_b64_tr_b16 v[242:243], v28 offset:29696
  ds_read_b64_tr_b16 v[244:245], v8 offset:28672
  ds_read_b64_tr_b16 v[246:247], v8 offset:29696
  v_mfma_f32_32x32x16_bf16 v[80:95], v[220:223], v[172:175], v[80:95]
  s_mov_b64 exec, s[78:79]
  buffer_load_dwordx4 v[156:159], v2, s[36:39], s75 offen offset:1024 sc1
  s_mov_b64 exec, -1
  s_waitcnt vmcnt(11) lgkmcnt(8)
  v_mfma_f32_32x32x16_bf16 v[64:79], v[224:227], v[176:179], v[64:79]
  ds_read_b64_tr_b16 v[248:249], v28 offset:30720
  ds_read_b64_tr_b16 v[250:251], v28 offset:31744
  ds_read_b64_tr_b16 v[252:253], v8 offset:30720
  ds_read_b64_tr_b16 v[254:255], v8 offset:31744
  v_mfma_f32_32x32x16_bf16 v[80:95], v[228:231], v[176:179], v[80:95]
  v_cmp_ne_u32 vcc, s56, v13
  s_nop 3
  s_and_b32 s76, vcc_lo, 0x55551111
  s_and_b32 s77, s76, 0x44440000
  s_cselect_b64 s[80:81], 1, -1
  s_mov_b64 exec, s[80:81]
  buffer_load_dwordx4 v[160:163], v2, s[36:39], s72 offen offset:2048 sc1
  s_mov_b64 exec, -1
  s_waitcnt vmcnt(11) lgkmcnt(8)
  v_mfma_f32_32x32x16_bf16 v[64:79], v[232:235], v[180:183], v[64:79]
  ds_read_b64_tr_b16 v[192:193], v29 offset:0
  ds_read_b64_tr_b16 v[194:195], v29 offset:1024
  ds_read_b64_tr_b16 v[196:197], v9 offset:0
  ds_read_b64_tr_b16 v[198:199], v9 offset:1024
  v_mfma_f32_32x32x16_bf16 v[80:95], v[236:239], v[180:183], v[80:95]
  s_mov_b64 exec, s[80:81]
  buffer_load_dwordx4 v[164:167], v2, s[36:39], s72 offen offset:3072 sc1
  s_mov_b64 exec, -1
  s_waitcnt vmcnt(11) lgkmcnt(8)
  v_mfma_f32_32x32x16_bf16 v[64:79], v[240:243], v[184:187], v[64:79]
  ds_read_b64_tr_b16 v[200:201], v29 offset:2048
  ds_read_b64_tr_b16 v[202:203], v29 offset:3072
  ds_read_b64_tr_b16 v[204:205], v9 offset:2048
  ds_read_b64_tr_b16 v[206:207], v9 offset:3072
  v_mfma_f32_32x32x16_bf16 v[80:95], v[244:247], v[184:187], v[80:95]
  s_mov_b64 exec, s[80:81]
  buffer_load_dwordx4 v[168:171], v2, s[36:39], s73 offen offset:2048 sc1
  s_mov_b64 exec, -1
  s_waitcnt vmcnt(11) lgkmcnt(8)
  v_mfma_f32_32x32x16_bf16 v[64:79], v[248:251], v[188:191], v[64:79]
  ds_read_b64_tr_b16 v[208:209], v29 offset:8192
  ds_read_b64_tr_b16 v[210:211], v29 offset:9216
  ds_read_b64_tr_b16 v[212:213], v9 offset:8192
  ds_read_b64_tr_b16 v[214:215], v9 offset:9216
  v_mfma_f32_32x32x16_bf16 v[80:95], v[252:255], v[188:191], v[80:95]
  s_mov_b64 exec, s[80:81]
  buffer_load_dwordx4 v[172:175], v2, s[36:39], s73 offen offset:3072 sc1
  s_mov_b64 exec, -1
  s_cmp_eq_u32 s78, 1
  s_cbranch_scc1 L_t1
L_t1_ok:
  s_waitcnt vmcnt(11) lgkmcnt(8)
  v_mfma_f32_32x32x16_bf16 v[96:111], v[192:195], v[128:131], 0
  ds_read_b64_tr_b16 v[216:217], v29 offset:10240
  ds_read_b64_tr_b16 v[218:219], v29 offset:11264
  ds_read_b64_tr_b16 v[220:221], v9 offset:10240
  ds_read_b64_tr_b16 v[222:223], v9 offset:11264
  v_mfma_f32_32x32x16_bf16 v[112:127], v[196:199], v[128:131], 0
  s_mov_b64 exec, s[80:81]
  buffer_load_dwordx4 v[176:179], v2, s[36:39], s74 offen offset:2048 sc1
  s_mov_b64 exec, -1
  s_waitcnt vmcnt(11) lgkmcnt(8)
  v_mfma_f32_32x32x16_bf16 v[96:111], v[200:203], v[132:135], v[96:111]
  ds_read_b64_tr_b16 v[224:225], v29 offset:16384
  ds_read_b64_tr_b16 v[226:227], v29 offset:17408
  ds_read_b64_tr_b16 v[228:229], v9 offset:16384
  ds_read_b64_tr_b16 v[230:231], v9 offset:17408
  v_mfma_f32_32x32x16_bf16 v[112:127], v[204:207], v[132:135], v[112:127]
  s_mov_b64 exec, s[80:81]
  buffer_load_dwordx4 v[180:183], v2, s[36:39], s74 offen offset:3072 sc1
  s_mov_b64 exec, -1
  s_waitcnt vmcnt(11) lgkmcnt(8)
  v_mfma_f32_32x32x16_bf16 v[96:111], v[208:211], v[136:139], v[96:111]
  ds_read_b64_tr_b16 v[232:233], v29 offset:18432
  ds_read_b64_tr_b16 v[234:235], v29 offset:19456
  ds_read_b64_tr_b16 v[236:237], v9 offset:18432
  ds_read_b64_tr_b16 v[238:239], v9 offset:19456
  v_mfma_f32_32x32x16_bf16 v[112:127], v[212:215], v[136:139], v[112:127]
  s_mov_b64 exec, s[80:81]
  buffer_load_dwordx4 v[184:187], v2, s[36:39], s75 offen offset:2048 sc1
  s_mov_b64 exec, -1
  s_waitcnt vmcnt(11) lgkmcnt(8)
  v_mfma_f32_32x32x16_bf16 v[96:111], v[216:219], v[140:143], v[96:111]
  ds_read_b64_tr_b16 v[240:241], v60 offset:24576
  ds_read_b64_tr_b16 v[242:243], v60 offset:25600
  ds_read_b64_tr_b16 v[244:245], v61 offset:24576
  ds_read_b64_tr_b16 v[246:247], v61 offset:25600
  v_mfma_f32_32x32x16_bf16 v[112:127], v[220:223], v[140:143], v[112:127]
  s_mov_b64 exec, s[80:81]
  buffer_load_dwordx4 v[188:191], v2, s[36:39], s75 offen offset:3072 sc1
  s_mov_b64 exec, -1
  s_waitcnt vmcnt(11) lgkmcnt(8)
  v_mfma_f32_32x32x16_bf16 v[96:111], v[224:227], v[144:147], v[96:111]
  ds_read_b64_tr_b16 v[248:249], v60 offset:26624
  ds_read_b64_tr_b16 v[250:251], v60 offset:27648
  ds_read_b64_tr_b16 v[252:253], v61 offset:26624
  ds_read_b64_tr_b16 v[254:255], v61 offset:27648
  v_mfma_f32_32x32x16_bf16 v[112:127], v[228:231], v[144:147], v[112:127]
  s_waitcnt vmcnt(10) lgkmcnt(8)
  v_mfma_f32_32x32x16_bf16 v[96:111], v[232:235], v[148:151], v[96:111]
  ds_read_b64_tr_b16 v[192:193], v29 offset:4096
  ds_read_b64_tr_b16 v[194:195], v29 offset:5120
  ds_read_b64_tr_b16 v[196:197], v9 offset:4096
  ds_read_b64_tr_b16 v[198:199], v9 offset:5120
  v_mfma_f32_32x32x16_bf16 v[112:127], v[236:239], v[148:151], v[112:127]
  s_waitcnt vmcnt(9) lgkmcnt(8)
  v_mfma_f32_32x32x16_bf16 v[96:111], v[240:243], v[152:155], v[96:111]
  ds_read_b64_tr_b16 v[200:201], v29 offset:6144
  ds_read_b64_tr_b16 v[202:203], v29 offset:7168
  ds_read_b64_tr_b16 v[204:205], v9 offset:6144
  ds_read_b64_tr_b16 v[206:207], v9 offset:7168
  v_mfma_f32_32x32x16_bf16 v[112:127], v[244:247], v[152:155], v[112:127]
  s_waitcnt vmcnt(8) lgkmcnt(8)
  v_mfma_f32_32x32x16_bf16 v[96:111], v[248:251], v[156:159], v[96:111]
  ds_read_b64_tr_b16 v[208:209], v29 offset:12288
  ds_read_b64_tr_b16 v[210:211], v29 offset:13312
  ds_read_b64_tr_b16 v[212:213], v9 offset:12288
  ds_read_b64_tr_b16 v[214:215], v9 offset:13312
  v_mfma_f32_32x32x16_bf16 v[112:127], v[252:255], v[156:159], v[112:127]
  s_mov_b64 exec, -1
  v_cmpx_ne_u32 vcc, s56, v7
  s_nop 4
  s_cbranch_execnz L_sp20
L_sp20_ok:
  s_mov_b64 exec, -1
  v_pk_mul_f32 v[64:65], v[64:65], v[6:7] op_sel_hi:[1,0]
  v_pk_mul_f32 v[66:67], v[66:67], v[6:7] op_sel_hi:[1,0]
  v_pk_mul_f32 v[68:69], v[68:69], v[6:7] op_sel_hi:[1,0]
  v_pk_mul_f32 v[70:71], v[70:71], v[6:7] op_sel_hi:[1,0]
  v_pk_mul_f32 v[72:73], v[72:73], v[6:7] op_sel_hi:[1,0]
  v_pk_mul_f32 v[74:75], v[74:75], v[6:7] op_sel_hi:[1,0]
  v_pk_mul_f32 v[76:77], v[76:77], v[6:7] op_sel_hi:[1,0]
  v_pk_mul_f32 v[78:79], v[78:79], v[6:7] op_sel_hi:[1,0]
  v_pk_mul_f32 v[80:81], v[80:81], v[6:7] op_sel_hi:[1,0]
  v_pk_mul_f32 v[82:83], v[82:83], v[6:7] op_sel_hi:[1,0]
  v_pk_mul_f32 v[84:85], v[84:85], v[6:7] op_sel_hi:[1,0]
  v_pk_mul_f32 v[86:87], v[86:87], v[6:7] op_sel_hi:[1,0]
  v_pk_mul_f32 v[88:89], v[88:89], v[6:7] op_sel_hi:[1,0]
  v_pk_mul_f32 v[90:91], v[90:91], v[6:7] op_sel_hi:[1,0]
  v_pk_mul_f32 v[92:93], v[92:93], v[6:7] op_sel_hi:[1,0]
  v_pk_mul_f32 v[94:95], v[94:95], v[6:7] op_sel_hi:[1,0]
  v_sub_f32 v6, 1.0, v6
  s_cmp_eq_u32 s80, 1
  s_cbranch_scc1 L_t2
L_t2_ok:
  s_barrier
  s_waitcnt vmcnt(7) lgkmcnt(8)
  v_mfma_f32_32x32x16_bf16 v[96:111], v[192:195], v[160:163], v[96:111]
  ds_read_b64_tr_b16 v[216:217], v29 offset:14336
  ds_read_b64_tr_b16 v[218:219], v29 offset:15360
  ds_read_b64_tr_b16 v[220:221], v9 offset:14336
  ds_read_b64_tr_b16 v[222:223], v9 offset:15360
  v_mfma_f32_32x32x16_bf16 v[112:127], v[196:199], v[160:163], v[112:127]
  s_waitcnt vmcnt(6) lgkmcnt(8)
  v_mfma_f32_32x32x16_bf16 v[96:111], v[200:203], v[164:167], v[96:111]
  ds_read_b64_tr_b16 v[224:225], v29 offset:20480
  ds_read_b64_tr_b16 v[226:227], v29 offset:21504
  ds_read_b64_tr_b16 v[228:229], v9 offset:20480
  ds_read_b64_tr_b16 v[230:231], v9 offset:21504
  v_mfma_f32_32x32x16_bf16 v[112:127], v[204:207], v[164:167], v[112:127]
  s_waitcnt vmcnt(5) lgkmcnt(8)
  v_mfma_f32_32x32x16_bf16 v[96:111], v[208:211], v[168:171], v[96:111]
  ds_read_b64_tr_b16 v[232:233], v29 offset:22528
  ds_read_b64_tr_b16 v[234:235], v29 offset:23552
  ds_read_b64_tr_b16 v[236:237], v9 offset:22528
  ds_read_b64_tr_b16 v[238:239], v9 offset:23552
  v_mfma_f32_32x32x16_bf16 v[112:127], v[212:215], v[168:171], v[112:127]
  s_waitcnt vmcnt(4) lgkmcnt(8)
  v_mfma_f32_32x32x16_bf16 v[96:111], v[216:219], v[172:175], v[96:111]
  ds_read_b64_tr_b16 v[240:241], v60 offset:28672
  ds_read_b64_tr_b16 v[242:243], v60 offset:29696
  ds_read_b64_tr_b16 v[244:245], v61 offset:28672
  ds_read_b64_tr_b16 v[246:247], v61 offset:29696
  v_mfma_f32_32x32x16_bf16 v[112:127], v[220:223], v[172:175], v[112:127]
  s_waitcnt vmcnt(3) lgkmcnt(8)
  v_mfma_f32_32x32x16_bf16 v[96:111], v[224:227], v[176:179], v[96:111]
  ds_read_b64_tr_b16 v[248:249], v60 offset:30720
  ds_read_b64_tr_b16 v[250:251], v60 offset:31744
  ds_read_b64_tr_b16 v[252:253], v61 offset:30720
  ds_read_b64_tr_b16 v[254:255], v61 offset:31744
  v_mfma_f32_32x32x16_bf16 v[112:127], v[228:231], v[176:179], v[112:127]
  s_waitcnt vmcnt(2) lgkmcnt(8)
  v_mfma_f32_32x32x16_bf16 v[96:111], v[232:235], v[180:183], v[96:111]
  v_mfma_f32_32x32x16_bf16 v[112:127], v[236:239], v[180:183], v[112:127]
  s_waitcnt vmcnt(1) lgkmcnt(4)
  v_mfma_f32_32x32x16_bf16 v[96:111], v[240:243], v[184:187], v[96:111]
  v_mfma_f32_32x32x16_bf16 v[112:127], v[244:247], v[184:187], v[112:127]
  s_waitcnt vmcnt(0) lgkmcnt(0)
  v_mfma_f32_32x32x16_bf16 v[96:111], v[248:251], v[188:191], v[96:111]
  v_mfma_f32_32x32x16_bf16 v[112:127], v[252:255], v[188:191], v[112:127]
  v_xor_b32 v4, 8192, v30
  s_nop 9
  v_pk_fma_f32 v[64:65], v[96:97], v[6:7], v[64:65] op_sel_hi:[1,0,1]
  v_pk_fma_f32 v[66:67], v[98:99], v[6:7], v[66:67] op_sel_hi:[1,0,1]
  v_pk_fma_f32 v[68:69], v[100:101], v[6:7], v[68:69] op_sel_hi:[1,0,1]
  v_pk_fma_f32 v[70:71], v[102:103], v[6:7], v[70:71] op_sel_hi:[1,0,1]
  v_pk_fma_f32 v[72:73], v[104:105], v[6:7], v[72:73] op_sel_hi:[1,0,1]
  v_pk_fma_f32 v[74:75], v[106:107], v[6:7], v[74:75] op_sel_hi:[1,0,1]
  v_pk_fma_f32 v[76:77], v[108:109], v[6:7], v[76:77] op_sel_hi:[1,0,1]
  v_pk_fma_f32 v[78:79], v[110:111], v[6:7], v[78:79] op_sel_hi:[1,0,1]
  v_pk_fma_f32 v[80:81], v[112:113], v[6:7], v[80:81] op_sel_hi:[1,0,1]
  v_pk_fma_f32 v[82:83], v[114:115], v[6:7], v[82:83] op_sel_hi:[1,0,1]
  ds_write_b128 v30, v[80:83] offset:0
  v_pk_fma_f32 v[84:85], v[116:117], v[6:7], v[84:85] op_sel_hi:[1,0,1]
  v_pk_fma_f32 v[86:87], v[118:119], v[6:7], v[86:87] op_sel_hi:[1,0,1]
  ds_write_b128 v30, v[84:87] offset:1024
  v_pk_fma_f32 v[88:89], v[120:121], v[6:7], v[88:89] op_sel_hi:[1,0,1]
  v_pk_fma_f32 v[90:91], v[122:123], v[6:7], v[90:91] op_sel_hi:[1,0,1]
  ds_write_b128 v30, v[88:91] offset:2048
  v_pk_fma_f32 v[92:93], v[124:125], v[6:7], v[92:93] op_sel_hi:[1,0,1]
  v_pk_fma_f32 v[94:95], v[126:127], v[6:7], v[94:95] op_sel_hi:[1,0,1]
  ds_write_b128 v30, v[92:95] offset:3072
  s_waitcnt lgkmcnt(0)
  s_barrier
  ds_read_b128 v[96:99], v4 offset:0
  ds_read_b128 v[100:103], v4 offset:1024
  ds_read_b128 v[104:107], v4 offset:2048
  ds_read_b128 v[108:111], v4 offset:3072
  s_waitcnt lgkmcnt(2)
  v_pk_add_f32 v[64:65], v[64:65], v[96:97]
  v_pk_add_f32 v[66:67], v[66:67], v[98:99]
  v_pk_add_f32 v[68:69], v[68:69], v[100:101]
  v_pk_add_f32 v[70:71], v[70:71], v[102:103]
  v_cvt_pk_bf16_f32 v112, v64, v65
  v_cvt_pk_bf16_f32 v113, v66, v67
  v_cvt_pk_bf16_f32 v114, v68, v69
  v_cvt_pk_bf16_f32 v115, v70, v71
  s_nop 0
  v_permlane32_swap_b32 v112, v114
  v_permlane32_swap_b32 v113, v115
  buffer_store_dwordx4 v[112:115], v31, s[48:51], s27 offen offset:0
  s_waitcnt lgkmcnt(0)
  v_pk_add_f32 v[72:73], v[72:73], v[104:105]
  v_pk_add_f32 v[74:75], v[74:75], v[106:107]
  v_pk_add_f32 v[76:77], v[76:77], v[108:109]
  v_pk_add_f32 v[78:79], v[78:79], v[110:111]
  v_cvt_pk_bf16_f32 v116, v72, v73
  v_cvt_pk_bf16_f32 v117, v74, v75
  v_cvt_pk_bf16_f32 v118, v76, v77
  v_cvt_pk_bf16_f32 v119, v78, v79
  s_nop 0
  v_permlane32_swap_b32 v116, v118
  v_permlane32_swap_b32 v117, v119
  buffer_store_dwordx4 v[116:119], v31, s[48:51], s27 offen offset:32
L_exit:
  s_endpgm
L_gn0:
  s_mov_b32 s83, 131072
L_gn0_l:
  global_load_dword v14, v15, s[22:23] sc1
  s_waitcnt vmcnt(0)
  v_readfirstlane_b32 s56, v14
  s_nop 3
  s_cmp_lg_u32 s56, 0
  s_cbranch_scc1 L_gn0_ok
  s_sub_u32 s83, s83, 1
  s_cmp_lg_u32 s83, 0
  s_cbranch_scc1 L_gn0_l
  s_branch L_gn0_ok
L_xw1:
  s_mov_b32 s83, 131072
L_xw1_l:
  buffer_load_dwordx2 v[12:13], v0, s[36:39], s3 offen sc1
  s_waitcnt vmcnt(0)
  v_cmp_ne_u32 vcc, s56, v13
  s_nop 4
  s_cbranch_vccz L_xw1_ok
  s_sub_u32 s83, s83, 1
  s_cmp_lg_u32 s83, 0
  s_cbranch_scc1 L_xw1_l
  v_mov_b32 v12, -1
  s_branch L_xw1_ok
L_bo2:
  buffer_store_dwordx4 v[64:67], v2, s[36:39], s7 offen offset:0 sc1
  buffer_store_dwordx4 v[68:71], v2, s[36:39], s7 offen offset:1024 sc1
  s_branch L_bo2_r
L_bo3:
  buffer_store_dword v14, v15, s[36:39], s8 offen sc1
  s_branch L_bo3_r
L_ax0s:
  s_waitcnt lgkmcnt(0)
  s_mov_b64 exec, 15
  ds_write_b32 v8, v14
  s_mov_b64 exec, -1
  s_branch L_ax0
L_ax1s:
  s_waitcnt lgkmcnt(0)
  s_mov_b64 exec, 15
  ds_write_b32 v8, v14
  s_mov_b64 exec, -1
L_ax1:
  s_nop 0
  v_mfma_f32_32x32x16_bf16 v[208:223], v[140:143], v[84:87], v[208:223]
  s_branch L_att_e
L_sp6:
  s_mov_b32 s83, 131072
L_sp6_l:
  buffer_load_dword v13, v15, s[36:39], s8 offen sc1
  s_waitcnt vmcnt(0)
  v_cmpx_ne_u32 vcc, s56, v13
  s_nop 4
  s_cbranch_execz L_sp6_ok
  s_sleep 1
  s_sub_u32 s83, s83, 1
  s_cmp_lg_u32 s83, 0
  s_cbranch_scc1 L_sp6_l
  s_branch L_sp6_ok
L_lk:
  s_mov_b32 s83, 131072
L_lk_l:
  s_sleep 1
  ds_read_b32 v5, v4
  s_waitcnt lgkmcnt(0)
  v_cmp_ne_u32 vcc, s56, v5
  s_nop 4
  s_cbranch_vccz L_lk_ok
  s_sub_u32 s83, s83, 1
  s_cmp_lg_u32 s83, 0
  s_cbranch_scc1 L_lk_l
  s_branch L_lk_ok
L_gn7:
  s_mov_b32 s83, 131072
L_gn7_l:
  global_load_dword v14, v15, s[22:23] sc1
  s_waitcnt vmcnt(0)
  v_readfirstlane_b32 s56, v14
  s_nop 3
  s_cmp_lg_u32 s56, 0
  s_cbranch_scc1 L_gn7_ok
  s_sub_u32 s83, s83, 1
  s_cmp_lg_u32 s83, 0
  s_cbranch_scc1 L_gn7_l
  s_branch L_gn7_ok
L_xw8:
  s_mov_b32 s83, 131072
L_xw8_l:
  buffer_load_dwordx2 v[12:13], v0, s[36:39], s3 offen sc1
  s_waitcnt vmcnt(0)
  v_cmp_ne_u32 vcc, s56, v13
  s_nop 4
  s_cbranch_vccz L_xw8_ok
  s_sub_u32 s83, s83, 1
  s_cmp_lg_u32 s83, 0
  s_cbranch_scc1 L_xw8_l
  v_mov_b32 v12, -1
  s_branch L_xw8_ok
L_bo9:
  buffer_store_dword v14, v15, s[36:39], s8 offen sc1
  s_branch L_bo9_r
L_sp10:
  s_mov_b32 s83, 131072
L_sp10_l:
  buffer_load_dword v13, v26, s[36:39], s9 offen sc1
  s_waitcnt vmcnt(0)
  v_cmpx_ne_u32 vcc, s56, v13
  s_nop 4
  s_cbranch_execz L_sp10_ok
  s_sleep 1
  s_sub_u32 s83, s83, 1
  s_cmp_lg_u32 s83, 0
  s_cbranch_scc1 L_sp10_l
  s_branch L_sp10_ok
L_sp16:
  s_mov_b32 s83, 131072
L_sp16_l:
  buffer_load_dword v13, v26, s[36:39], s9 offen sc1
  s_waitcnt vmcnt(0)
  v_cmpx_ne_u32 vcc, s56, v13
  s_nop 4
  s_cbranch_execz L_sp16_ok
  s_sleep 1
  s_sub_u32 s83, s83, 1
  s_cmp_lg_u32 s83, 0
  s_cbranch_scc1 L_sp16_l
  s_branch L_sp16_ok
L_lf:
  s_mov_b32 s83, 131072
L_lf_l:
  s_sleep 1
  ds_read_b32 v5, v8
  s_waitcnt lgkmcnt(0)
  v_cmp_ne_u32 vcc, s56, v5
  s_nop 4
  s_cbranch_vccz L_lf_ok
  s_sub_u32 s83, s83, 1
  s_cmp_lg_u32 s83, 0
  s_cbranch_scc1 L_lf_l
  s_branch L_lf_ok
L_bo17:
  buffer_store_dwordx4 v[144:147], v25, s[36:39], s10 offen sc1
  buffer_store_dwordx4 v[148:151], v54, s[36:39], s10 offen offset:256 sc1
  s_branch L_bo17_r
L_bo18:
  buffer_store_dword v14, v15, s[36:39], s11 offen sc1
  s_branch L_bo18_r
L_sp19:
  s_mov_b32 s83, 131072
L_sp19_l:
  buffer_load_dword v13, v26, s[36:39], s14 offen sc1
  s_waitcnt vmcnt(0)
  v_cmpx_ne_u32 vcc, s56, v13
  s_nop 4
  s_cbranch_execz L_sp19_ok
  s_sleep 1
  s_sub_u32 s83, s83, 1
  s_cmp_lg_u32 s83, 0
  s_cbranch_scc1 L_sp19_l
  s_branch L_sp19_ok
L_le:
  s_mov_b32 s83, 131072
L_le_l:
  s_sleep 1
  ds_read_b32 v5, v4 offset:15376
  s_waitcnt lgkmcnt(0)
  v_cmp_ne_u32 vcc, s56, v5
  s_nop 4
  s_cbranch_vccz L_le_ok
  s_sub_u32 s83, s83, 1
  s_cmp_lg_u32 s83, 0
  s_cbranch_scc1 L_le_l
  s_branch L_le_ok
L_lp:
  s_mov_b32 s83, 131072
L_lp_l:
  s_sleep 1
  ds_read_b32 v5, v4 offset:15360
  s_waitcnt lgkmcnt(0)
  v_cmp_ne_u32 vcc, s56, v5
  s_nop 4
  s_cbranch_vccz L_lp_ok
  s_sub_u32 s83, s83, 1
  s_cmp_lg_u32 s83, 0
  s_cbranch_scc1 L_lp_l
  s_branch L_lp_ok
L_ta:
  s_mov_b32 s83, 131072
L_ta_l:
  s_and_b32 s77, s76, 0x1111
  s_cbranch_scc0 L_ta_d
  s_sleep 4
  s_mov_b32 exec_lo, s76
  s_mov_b32 exec_hi, 0
  buffer_load_dword v13, v11, s[36:39], s25 offen sc1
  s_waitcnt vmcnt(0)
  v_cmp_ne_u32 vcc, s56, v13
  s_nop 3
  s_and_b32 s76, vcc_lo, 0x55551111
  s_mov_b64 exec, -1
  s_sub_u32 s83, s83, 1
  s_cmp_gt_i32 s83, 0
  s_cbranch_scc1 L_ta_l
L_ta_d:
  s_branch L_ta_ok
L_lg:
  s_mov_b32 s83, 131072
L_lg_l:
  s_sleep 1
  ds_read_b32 v5, v10
  s_waitcnt lgkmcnt(0)
  v_cmp_ne_u32 vcc, s56, v5
  s_nop 4
  s_cbranch_vccz L_lg_ok
  s_sub_u32 s83, s83, 1
  s_cmp_lg_u32 s83, 0
  s_cbranch_scc1 L_lg_l
  s_branch L_lg_ok
L_t1:
  s_mov_b32 s83, 131072
L_t1_l:
  s_and_b32 s77, s76, 0x11110000
  s_cbranch_scc0 L_t1_d
  s_sleep 4
  s_mov_b32 exec_lo, s76
  s_mov_b32 exec_hi, 0
  buffer_load_dword v13, v11, s[36:39], s25 offen sc1
  s_waitcnt vmcnt(0)
  v_cmp_ne_u32 vcc, s56, v13
  s_nop 3
  s_and_b32 s76, vcc_lo, 0x55551111
  s_mov_b64 exec, -1
  s_sub_u32 s83, s83, 1
  s_cmp_gt_i32 s83, 0
  s_cbranch_scc1 L_t1_l
L_t1_d:
  s_mov_b64 s[78:79], -1
  s_and_b32 s77, s76, 0x44440000
  s_cselect_b64 s[80:81], 1, -1
  buffer_load_dwordx4 v[128:131], v2, s[36:39], s72 offen offset:0 sc1
  buffer_load_dwordx4 v[132:135], v2, s[36:39], s72 offen offset:1024 sc1
  buffer_load_dwordx4 v[136:139], v2, s[36:39], s73 offen offset:0 sc1
  buffer_load_dwordx4 v[140:143], v2, s[36:39], s73 offen offset:1024 sc1
  buffer_load_dwordx4 v[144:147], v2, s[36:39], s74 offen offset:0 sc1
  buffer_load_dwordx4 v[148:151], v2, s[36:39], s74 offen offset:1024 sc1
  buffer_load_dwordx4 v[152:155], v2, s[36:39], s75 offen offset:0 sc1
  buffer_load_dwordx4 v[156:159], v2, s[36:39], s75 offen offset:1024 sc1
  s_mov_b64 exec, s[80:81]
  buffer_load_dwordx4 v[160:163], v2, s[36:39], s72 offen offset:2048 sc1
  s_mov_b64 exec, -1
  s_mov_b64 exec, s[80:81]
  buffer_load_dwordx4 v[164:167], v2, s[36:39], s72 offen offset:3072 sc1
  s_mov_b64 exec, -1
  s_mov_b64 exec, s[80:81]
  buffer_load_dwordx4 v[168:171], v2, s[36:39], s73 offen offset:2048 sc1
  s_mov_b64 exec, -1
  s_mov_b64 exec, s[80:81]
  buffer_load_dwordx4 v[172:175], v2, s[36:39], s73 offen offset:3072 sc1
  s_mov_b64 exec, -1
  s_branch L_t1_ok
L_sp20:
  s_mov_b32 s83, 131072
L_sp20_l:
  buffer_load_dwordx2 v[6:7], v0, s[36:39], s26 offen sc1
  s_waitcnt vmcnt(0)
  v_cmpx_ne_u32 vcc, s56, v7
  s_nop 4
  s_cbranch_execz L_sp20_ok
  s_sleep 1
  s_sub_u32 s83, s83, 1
  s_cmp_lg_u32 s83, 0
  s_cbranch_scc1 L_sp20_l
  s_branch L_sp20_ok
L_t2:
  s_mov_b32 s78, 0x44440000
  s_mov_b32 s83, 131072
L_t2_r:
  s_mov_b32 exec_lo, s78
  s_mov_b32 exec_hi, 0
  buffer_load_dword v13, v11, s[36:39], s25 offen sc1
  s_waitcnt vmcnt(0)
  v_cmp_ne_u32 vcc, s56, v13
  s_nop 3
  s_and_b32 s76, vcc_lo, 0x55551111
  s_mov_b64 exec, -1
  s_sub_u32 s83, s83, 1
  s_cmp_gt_i32 s83, 0
  s_cselect_b32 s76, s76, 0
  s_andn2_b32 s77, s78, s76
  s_bitcmp1_b32 s77, 18
  s_cbranch_scc0 L_t2_s0
  buffer_load_dwordx4 v[160:163], v2, s[36:39], s72 offen offset:2048 sc1
  buffer_load_dwordx4 v[164:167], v2, s[36:39], s72 offen offset:3072 sc1
L_t2_s0:
  s_bitcmp1_b32 s77, 22
  s_cbranch_scc0 L_t2_s1
  buffer_load_dwordx4 v[168:171], v2, s[36:39], s73 offen offset:2048 sc1
  buffer_load_dwordx4 v[172:175], v2, s[36:39], s73 offen offset:3072 sc1
L_t2_s1:
  s_bitcmp1_b32 s77, 26
  s_cbranch_scc0 L_t2_s2
  buffer_load_dwordx4 v[176:179], v2, s[36:39], s74 offen offset:2048 sc1
  buffer_load_dwordx4 v[180:183], v2, s[36:39], s74 offen offset:3072 sc1
L_t2_s2:
  s_bitcmp1_b32 s77, 30
  s_cbranch_scc0 L_t2_s3
  buffer_load_dwordx4 v[184:187], v2, s[36:39], s75 offen offset:2048 sc1
  buffer_load_dwordx4 v[188:191], v2, s[36:39], s75 offen offset:3072 sc1
L_t2_s3:
  s_and_b32 s78, s78, s76
  s_cbranch_scc1 L_t2_r
  s_waitcnt vmcnt(0)
  s_branch L_t2_ok
L_coldstart:
L_afb0:
  s_waitcnt lgkmcnt(0)
  v_sub_u32 v7, v45, v44
  v_add_u32 v7, v7, v2
  v_mov_b32 v4, 0xff7fffff
  s_add_u32 s64, s12, 0
  s_mov_b32 s65, 0
L_am0:
  buffer_load_dwordx4 v[88:91], v2, s[36:39], s64 offen sc1
  s_waitcnt vmcnt(0)
  s_cmp_eq_u32 s65, 0
  s_cbranch_scc1 L_am0d
  s_cmp_eq_u32 s65, 8
  s_cbranch_scc1 L_am0f
  v_mfma_f32_32x32x16_bf16 v[160:175], v[88:91], v[72:75], 0
  s_branch L_am0e
L_am0d:
  v_mfma_f32_32x32x16_bf16 v[160:175], v[88:91], v[72:75], v[96:111]
  s_branch L_am0e
L_am0f:
  v_mfma_f32_32x32x16_bf16 v[160:175], v[88:91], v[72:75], v[112:127]
L_am0e:
  s_nop 11
  v_max3_f32 v4, v4, v160, v161
  v_max3_f32 v4, v4, v162, v163
  v_max3_f32 v4, v4, v164, v165
  v_max3_f32 v4, v4, v166, v167
  v_max3_f32 v4, v4, v168, v169
  v_max3_f32 v4, v4, v170, v171
  v_max3_f32 v4, v4, v172, v173
  v_max3_f32 v4, v4, v174, v175
  s_sub_u32 s64, s64, 2048
  s_add_u32 s65, s65, 1
  s_cmp_le_u32 s65, s6
  s_cbranch_scc1 L_am0
  v_mov_b32 v5, v4
  s_nop 1
  v_permlane32_swap_b32 v4, v5
  v_max_f32 v4, v4, v5
  v_mov_b32 v192, 0
  v_mov_b32 v193, 0
  v_mov_b32 v194, 0
  v_mov_b32 v195, 0
  v_mov_b32 v196, 0
  v_mov_b32 v197, 0
  v_mov_b32 v198, 0
  v_mov_b32 v199, 0
  v_mov_b32 v200, 0
  v_mov_b32 v201, 0
  v_mov_b32 v202, 0
  v_mov_b32 v203, 0
  v_mov_b32 v204, 0
  v_mov_b32 v205, 0
  v_mov_b32 v206, 0
  v_mov_b32 v207, 0
  s_add_u32 s64, s12, 0
  s_mov_b32 s65, 0
L_ap0:
  buffer_load_dwordx4 v[88:91], v2, s[36:39], s64 offen sc1
  s_mov_b64 exec, s[60:61]
  buffer_load_dwordx4 v[144:147], v7, s[36:39], s64 offen sc1
  buffer_load_dwordx4 v[148:151], v7, s[36:39], s64 offen offset:512 sc1
  s_mov_b64 exec, -1
  s_waitcnt vmcnt(0)
  s_cmp_eq_u32 s65, 0
  s_cbranch_scc1 L_ap0d
  s_cmp_eq_u32 s65, 8
  s_cbranch_scc1 L_ap0f
  v_mfma_f32_32x32x16_bf16 v[160:175], v[88:91], v[72:75], 0
  s_branch L_ap0e
L_ap0d:
  v_mfma_f32_32x32x16_bf16 v[160:175], v[88:91], v[72:75], v[96:111]
  s_branch L_ap0e
L_ap0f:
  v_mfma_f32_32x32x16_bf16 v[160:175], v[88:91], v[72:75], v[112:127]
L_ap0e:
  s_nop 11
  v_sub_f32 v160, v160, v4
  v_sub_f32 v161, v161, v4
  v_sub_f32 v162, v162, v4
  v_sub_f32 v163, v163, v4
  v_sub_f32 v164, v164, v4
  v_sub_f32 v165, v165, v4
  v_sub_f32 v166, v166, v4
  v_sub_f32 v167, v167, v4
  v_sub_f32 v168, v168, v4
  v_sub_f32 v169, v169, v4
  v_sub_f32 v170, v170, v4
  v_sub_f32 v171, v171, v4
  v_sub_f32 v172, v172, v4
  v_sub_f32 v173, v173, v4
  v_sub_f32 v174, v174, v4
  v_sub_f32 v175, v175, v4
  v_exp_f32 v160, v160
  v_exp_f32 v161, v161
  v_exp_f32 v162, v162
  v_exp_f32 v163, v163
  v_exp_f32 v164, v164
  v_exp_f32 v165, v165
  v_exp_f32 v166, v166
  v_exp_f32 v167, v167
  v_exp_f32 v168, v168
  v_exp_f32 v169, v169
  v_exp_f32 v170, v170
  v_exp_f32 v171, v171
  v_exp_f32 v172, v172
  v_exp_f32 v173, v173
  v_exp_f32 v174, v174
  v_exp_f32 v175, v175
  v_cvt_pk_bf16_f32 v80, v160, v161
  v_cvt_pk_bf16_f32 v81, v162, v163
  v_cvt_pk_bf16_f32 v82, v164, v165
  v_cvt_pk_bf16_f32 v83, v166, v167
  v_cvt_pk_bf16_f32 v84, v168, v169
  v_cvt_pk_bf16_f32 v85, v170, v171
  v_cvt_pk_bf16_f32 v86, v172, v173
  v_cvt_pk_bf16_f32 v87, v174, v175
  v_mfma_f32_32x32x16_bf16 v[192:207], v[144:147], v[80:83], v[192:207]
  s_nop 0
  v_mfma_f32_32x32x16_bf16 v[192:207], v[148:151], v[84:87], v[192:207]
  s_sub_u32 s64, s64, 2048
  s_add_u32 s65, s65, 1
  s_cmp_le_u32 s65, s6
  s_cbranch_scc1 L_ap0
  s_nop 7
  v_rcp_f32 v6, v200
  s_branch L_afb0_r
L_afb1:
  s_waitcnt lgkmcnt(0)
  v_sub_u32 v7, v45, v44
  v_add_u32 v7, v7, v2
  v_mov_b32 v4, 0xff7fffff
  s_add_u32 s64, s12, 131072
  s_mov_b32 s65, 0
L_am1:
  buffer_load_dwordx4 v[88:91], v2, s[36:39], s64 offen sc1
  s_waitcnt vmcnt(0)
  s_cmp_eq_u32 s65, 0
  s_cbranch_scc1 L_am1d
  s_cmp_eq_u32 s65, 8
  s_cbranch_scc1 L_am1f
  v_mfma_f32_32x32x16_bf16 v[160:175], v[88:91], v[76:79], 0
  s_branch L_am1e
L_am1d:
  v_mfma_f32_32x32x16_bf16 v[160:175], v[88:91], v[76:79], v[96:111]
  s_branch L_am1e
L_am1f:
  v_mfma_f32_32x32x16_bf16 v[160:175], v[88:91], v[76:79], v[112:127]
L_am1e:
  s_nop 11
  v_max3_f32 v4, v4, v160, v161
  v_max3_f32 v4, v4, v162, v163
  v_max3_f32 v4, v4, v164, v165
  v_max3_f32 v4, v4, v166, v167
  v_max3_f32 v4, v4, v168, v169
  v_max3_f32 v4, v4, v170, v171
  v_max3_f32 v4, v4, v172, v173
  v_max3_f32 v4, v4, v174, v175
  s_sub_u32 s64, s64, 2048
  s_add_u32 s65, s65, 1
  s_cmp_le_u32 s65, s6
  s_cbranch_scc1 L_am1
  v_mov_b32 v5, v4
  s_nop 1
  v_permlane32_swap_b32 v4, v5
  v_max_f32 v4, v4, v5
  v_mov_b32 v208, 0
  v_mov_b32 v209, 0
  v_mov_b32 v210, 0
  v_mov_b32 v211, 0
  v_mov_b32 v212, 0
  v_mov_b32 v213, 0
  v_mov_b32 v214, 0
  v_mov_b32 v215, 0
  v_mov_b32 v216, 0
  v_mov_b32 v217, 0
  v_mov_b32 v218, 0
  v_mov_b32 v219, 0
  v_mov_b32 v220, 0
  v_mov_b32 v221, 0
  v_mov_b32 v222, 0
  v_mov_b32 v223, 0
  s_add_u32 s64, s12, 131072
  s_mov_b32 s65, 0
L_ap1:
  buffer_load_dwordx4 v[88:91], v2, s[36:39], s64 offen sc1
  s_mov_b64 exec, s[60:61]
  buffer_load_dwordx4 v[144:147], v7, s[36:39], s64 offen sc1
  buffer_load_dwordx4 v[148:151], v7, s[36:39], s64 offen offset:512 sc1
  s_mov_b64 exec, -1
  s_waitcnt vmcnt(0)
  s_cmp_eq_u32 s65, 0
  s_cbranch_scc1 L_ap1d
  s_cmp_eq_u32 s65, 8
  s_cbranch_scc1 L_ap1f
  v_mfma_f32_32x32x16_bf16 v[160:175], v[88:91], v[76:79], 0
  s_branch L_ap1e
L_ap1d:
  v_mfma_f32_32x32x16_bf16 v[160:175], v[88:91], v[76:79], v[96:111]
  s_branch L_ap1e
L_ap1f:
  v_mfma_f32_32x32x16_bf16 v[160:175], v[88:91], v[76:79], v[112:127]
L_ap1e:
  s_nop 11
  v_sub_f32 v160, v160, v4
  v_sub_f32 v161, v161, v4
  v_sub_f32 v162, v162, v4
  v_sub_f32 v163, v163, v4
  v_sub_f32 v164, v164, v4
  v_sub_f32 v165, v165, v4
  v_sub_f32 v166, v166, v4
  v_sub_f32 v167, v167, v4
  v_sub_f32 v168, v168, v4
  v_sub_f32 v169, v169, v4
  v_sub_f32 v170, v170, v4
  v_sub_f32 v171, v171, v4
  v_sub_f32 v172, v172, v4
  v_sub_f32 v173, v173, v4
  v_sub_f32 v174, v174, v4
  v_sub_f32 v175, v175, v4
  v_exp_f32 v160, v160
  v_exp_f32 v161, v161
  v_exp_f32 v162, v162
  v_exp_f32 v163, v163
  v_exp_f32 v164, v164
  v_exp_f32 v165, v165
  v_exp_f32 v166, v166
  v_exp_f32 v167, v167
  v_exp_f32 v168, v168
  v_exp_f32 v169, v169
  v_exp_f32 v170, v170
  v_exp_f32 v171, v171
  v_exp_f32 v172, v172
  v_exp_f32 v173, v173
  v_exp_f32 v174, v174
  v_exp_f32 v175, v175
  v_cvt_pk_bf16_f32 v80, v160, v161
  v_cvt_pk_bf16_f32 v81, v162, v163
  v_cvt_pk_bf16_f32 v82, v164, v165
  v_cvt_pk_bf16_f32 v83, v166, v167
  v_cvt_pk_bf16_f32 v84, v168, v169
  v_cvt_pk_bf16_f32 v85, v170, v171
  v_cvt_pk_bf16_f32 v86, v172, v173
  v_cvt_pk_bf16_f32 v87, v174, v175
  v_mfma_f32_32x32x16_bf16 v[208:223], v[144:147], v[80:83], v[208:223]
  s_nop 0
  v_mfma_f32_32x32x16_bf16 v[208:223], v[148:151], v[84:87], v[208:223]
  s_sub_u32 s64, s64, 2048
  s_add_u32 s65, s65, 1
  s_cmp_le_u32 s65, s6
  s_cbranch_scc1 L_ap1
  s_nop 7
  v_rcp_f32 v6, v216
  s_branch L_afb1_r
L_qg4:
  v_max3_f32 v16, v160, v161, v162
  v_max3_f32 v16, v16, v163, v164
  v_max3_f32 v16, v16, v165, v166
  v_max_f32 v16, v16, v167
  v_max3_f32 v18, v168, v169, v170
  v_max3_f32 v18, v18, v171, v172
  v_max3_f32 v18, v18, v173, v174
  v_max_f32 v18, v18, v175
  s_nop 1
  v_permlane32_swap_b32 v16, v18
  v_max_f32 v16, v16, v18
  v_mov_b32 v18, v16
  s_nop 1
  v_permlane32_swap_b32 v16, v18
  v_sub_f32 v160, v160, v16
  v_sub_f32 v161, v161, v16
  v_sub_f32 v162, v162, v16
  v_sub_f32 v163, v163, v16
  v_sub_f32 v164, v164, v16
  v_sub_f32 v165, v165, v16
  v_sub_f32 v166, v166, v16
  v_sub_f32 v167, v167, v16
  v_sub_f32 v168, v168, v18
  v_sub_f32 v169, v169, v18
  v_sub_f32 v170, v170, v18
  v_sub_f32 v171, v171, v18
  v_sub_f32 v172, v172, v18
  v_sub_f32 v173, v173, v18
  v_sub_f32 v174, v174, v18
  v_sub_f32 v175, v175, v18
  v_max3_f32 v16, v176, v177, v178
  v_max3_f32 v16, v16, v179, v180
  v_max3_f32 v16, v16, v181, v182
  v_max_f32 v16, v16, v183
  v_max3_f32 v18, v184, v185, v186
  v_max3_f32 v18, v18, v187, v188
  v_max3_f32 v18, v18, v189, v190
  v_max_f32 v18, v18, v191
  s_nop 1
  v_permlane32_swap_b32 v16, v18
  v_max_f32 v16, v16, v18
  v_mov_b32 v18, v16
  s_nop 1
  v_permlane32_swap_b32 v16, v18
  v_sub_f32 v176, v176, v16
  v_sub_f32 v177, v177, v16
  v_sub_f32 v178, v178, v16
  v_sub_f32 v179, v179, v16
  v_sub_f32 v180, v180, v16
  v_sub_f32 v181, v181, v16
  v_sub_f32 v182, v182, v16
  v_sub_f32 v183, v183, v16
  v_sub_f32 v184, v184, v18
  v_sub_f32 v185, v185, v18
  v_sub_f32 v186, v186, v18
  v_sub_f32 v187, v187, v18
  v_sub_f32 v188, v188, v18
  v_sub_f32 v189, v189, v18
  v_sub_f32 v190, v190, v18
  v_sub_f32 v191, v191, v18
  s_branch L_qg4_r
L_qg5:
  v_max3_f32 v16, v192, v193, v194
  v_max3_f32 v16, v16, v195, v196
  v_max3_f32 v16, v16, v197, v198
  v_max_f32 v16, v16, v199
  v_max3_f32 v18, v200, v201, v202
  v_max3_f32 v18, v18, v203, v204
  v_max3_f32 v18, v18, v205, v206
  v_max_f32 v18, v18, v207
  s_nop 1
  v_permlane32_swap_b32 v16, v18
  v_max_f32 v16, v16, v18
  v_mov_b32 v18, v16
  s_nop 1
  v_permlane32_swap_b32 v16, v18
  v_sub_f32 v192, v192, v16
  v_sub_f32 v193, v193, v16
  v_sub_f32 v194, v194, v16
  v_sub_f32 v195, v195, v16
  v_sub_f32 v196, v196, v16
  v_sub_f32 v197, v197, v16
  v_sub_f32 v198, v198, v16
  v_sub_f32 v199, v199, v16
  v_sub_f32 v200, v200, v18
  v_sub_f32 v201, v201, v18
  v_sub_f32 v202, v202, v18
  v_sub_f32 v203, v203, v18
  v_sub_f32 v204, v204, v18
  v_sub_f32 v205, v205, v18
  v_sub_f32 v206, v206, v18
  v_sub_f32 v207, v207, v18
  v_max3_f32 v16, v208, v209, v210
  v_max3_f32 v16, v16, v211, v212
  v_max3_f32 v16, v16, v213, v214
  v_max_f32 v16, v16, v215
  v_max3_f32 v18, v216, v217, v218
  v_max3_f32 v18, v18, v219, v220
  v_max3_f32 v18, v18, v221, v222
  v_max_f32 v18, v18, v223
  s_nop 1
  v_permlane32_swap_b32 v16, v18
  v_max_f32 v16, v16, v18
  v_mov_b32 v18, v16
  s_nop 1
  v_permlane32_swap_b32 v16, v18
  v_sub_f32 v208, v208, v16
  v_sub_f32 v209, v209, v16
  v_sub_f32 v210, v210, v16
  v_sub_f32 v211, v211, v16
  v_sub_f32 v212, v212, v16
  v_sub_f32 v213, v213, v16
  v_sub_f32 v214, v214, v16
  v_sub_f32 v215, v215, v16
  v_sub_f32 v216, v216, v18
  v_sub_f32 v217, v217, v18
  v_sub_f32 v218, v218, v18
  v_sub_f32 v219, v219, v18
  v_sub_f32 v220, v220, v18
  v_sub_f32 v221, v221, v18
  v_sub_f32 v222, v222, v18
  v_sub_f32 v223, v223, v18
  s_branch L_qg5_r
L_fb14:
  v_mfma_f32_32x32x16_bf16 v[192:207], v[36:39], v[64:67], 0
  v_mfma_f32_32x32x16_bf16 v[208:223], v[40:43], v[68:71], 0
  s_nop 10
  v_max3_f32 v112, v192, v193, v194
  v_max3_f32 v112, v112, v195, v196
  v_max3_f32 v112, v112, v197, v198
  v_max_f32 v112, v112, v199
  v_max3_f32 v114, v200, v201, v202
  v_max3_f32 v114, v114, v203, v204
  v_max3_f32 v114, v114, v205, v206
  v_max_f32 v114, v114, v207
  v_max3_f32 v116, v208, v209, v210
  v_max3_f32 v116, v116, v211, v212
  v_max3_f32 v116, v116, v213, v214
  v_max_f32 v116, v116, v215
  v_max3_f32 v118, v216, v217, v218
  v_max3_f32 v118, v118, v219, v220
  v_max3_f32 v118, v118, v221, v222
  v_max_f32 v118, v118, v223
  v_permlane32_swap_b32 v112, v114
  s_nop 0
  v_permlane32_swap_b32 v116, v118
  v_max_f32 v112, v112, v114
  v_max_f32 v116, v116, v118
  v_mov_b32 v114, v112
  v_mov_b32 v118, v116
  s_nop 0
  v_permlane32_swap_b32 v112, v114
  v_permlane32_swap_b32 v116, v118
  v_sub_f32 v192, v192, v112
  v_sub_f32 v193, v193, v112
  v_sub_f32 v194, v194, v112
  v_sub_f32 v195, v195, v112
  v_sub_f32 v196, v196, v112
  v_sub_f32 v197, v197, v112
  v_sub_f32 v198, v198, v112
  v_sub_f32 v199, v199, v112
  v_sub_f32 v200, v200, v114
  v_sub_f32 v201, v201, v114
  v_sub_f32 v202, v202, v114
  v_sub_f32 v203, v203, v114
  v_sub_f32 v204, v204, v114
  v_sub_f32 v205, v205, v114
  v_sub_f32 v206, v206, v114
  v_sub_f32 v207, v207, v114
  v_sub_f32 v208, v208, v116
  v_sub_f32 v209, v209, v116
  v_sub_f32 v210, v210, v116
  v_sub_f32 v211, v211, v116
  v_sub_f32 v212, v212, v116
  v_sub_f32 v213, v213, v116
  v_sub_f32 v214, v214, v116
  v_sub_f32 v215, v215, v116
  v_sub_f32 v216, v216, v118
  v_sub_f32 v217, v217, v118
  v_sub_f32 v218, v218, v118
  v_sub_f32 v219, v219, v118
  v_sub_f32 v220, v220, v118
  v_sub_f32 v221, v221, v118
  v_sub_f32 v222, v222, v118
  v_sub_f32 v223, v223, v118
  v_exp_f32 v192, v192
  v_exp_f32 v193, v193
  v_exp_f32 v194, v194
  v_exp_f32 v195, v195
  v_exp_f32 v196, v196
  v_exp_f32 v197, v197
  v_exp_f32 v198, v198
  v_exp_f32 v199, v199
  v_exp_f32 v200, v200
  v_exp_f32 v201, v201
  v_exp_f32 v202, v202
  v_exp_f32 v203, v203
  v_exp_f32 v204, v204
  v_exp_f32 v205, v205
  v_exp_f32 v206, v206
  v_exp_f32 v207, v207
  v_exp_f32 v208, v208
  v_exp_f32 v209, v209
  v_exp_f32 v210, v210
  v_exp_f32 v211, v211
  v_exp_f32 v212, v212
  v_exp_f32 v213, v213
  v_exp_f32 v214, v214
  v_exp_f32 v215, v215
  v_exp_f32 v216, v216
  v_exp_f32 v217, v217
  v_exp_f32 v218, v218
  v_exp_f32 v219, v219
  v_exp_f32 v220, v220
  v_exp_f32 v221, v221
  v_exp_f32 v222, v222
  v_exp_f32 v223, v223
  v_add_f32 v112, v192, v193
  v_add_f32 v113, v194, v195
  v_add_f32 v114, v200, v201
  v_add_f32 v115, v202, v203
  v_add_f32 v112, v112, v196
  v_add_f32 v114, v114, v204
  v_add_f32 v113, v113, v197
  v_add_f32 v115, v115, v205
  v_add_f32 v112, v112, v198
  v_add_f32 v114, v114, v206
  v_add_f32 v113, v113, v199
  v_add_f32 v115, v115, v207
  v_add_f32 v112, v112, v113
  v_add_f32 v114, v114, v115
  v_add_f32 v116, v208, v209
  v_add_f32 v117, v210, v211
  v_add_f32 v118, v216, v217
  v_add_f32 v119, v218, v219
  v_add_f32 v116, v116, v212
  v_add_f32 v118, v118, v220
  v_add_f32 v117, v117, v213
  v_add_f32 v119, v119, v221
  v_add_f32 v116, v116, v214
  v_add_f32 v118, v118, v222
  v_add_f32 v117, v117, v215
  v_add_f32 v119, v119, v223
  v_add_f32 v116, v116, v117
  v_add_f32 v118, v118, v119
  v_permlane32_swap_b32 v112, v114
  s_nop 0
  v_permlane32_swap_b32 v116, v118
  v_add_f32 v112, v112, v114
  v_add_f32 v116, v116, v118
  v_rcp_f32 v114, v112
  v_rcp_f32 v118, v116
  s_branch L_fb14_r
L_fb15:
  v_mfma_f32_32x32x16_bf16 v[128:143], v[36:39], v[72:75], 0
  v_mfma_f32_32x32x16_bf16 v[144:159], v[40:43], v[76:79], 0
  s_nop 10
  v_max3_f32 v112, v128, v129, v130
  v_max3_f32 v112, v112, v131, v132
  v_max3_f32 v112, v112, v133, v134
  v_max_f32 v112, v112, v135
  v_max3_f32 v114, v136, v137, v138
  v_max3_f32 v114, v114, v139, v140
  v_max3_f32 v114, v114, v141, v142
  v_max_f32 v114, v114, v143
  v_max3_f32 v116, v144, v145, v146
  v_max3_f32 v116, v116, v147, v148
  v_max3_f32 v116, v116, v149, v150
  v_max_f32 v116, v116, v151
  v_max3_f32 v118, v152, v153, v154
  v_max3_f32 v118, v118, v155, v156
  v_max3_f32 v118, v118, v157, v158
  v_max_f32 v118, v118, v159
  v_permlane32_swap_b32 v112, v114
  s_nop 0
  v_permlane32_swap_b32 v116, v118
  v_max_f32 v112, v112, v114
  v_max_f32 v116, v116, v118
  v_mov_b32 v114, v112
  v_mov_b32 v118, v116
  s_nop 0
  v_permlane32_swap_b32 v112, v114
  v_permlane32_swap_b32 v116, v118
  v_sub_f32 v128, v128, v112
  v_sub_f32 v129, v129, v112
  v_sub_f32 v130, v130, v112
  v_sub_f32 v131, v131, v112
  v_sub_f32 v132, v132, v112
  v_sub_f32 v133, v133, v112
  v_sub_f32 v134, v134, v112
  v_sub_f32 v135, v135, v112
  v_sub_f32 v136, v136, v114
  v_sub_f32 v137, v137, v114
  v_sub_f32 v138, v138, v114
  v_sub_f32 v139, v139, v114
  v_sub_f32 v140, v140, v114
  v_sub_f32 v141, v141, v114
  v_sub_f32 v142, v142, v114
  v_sub_f32 v143, v143, v114
  v_sub_f32 v144, v144, v116
  v_sub_f32 v145, v145, v116
  v_sub_f32 v146, v146, v116
  v_sub_f32 v147, v147, v116
  v_sub_f32 v148, v148, v116
  v_sub_f32 v149, v149, v116
  v_sub_f32 v150, v150, v116
  v_sub_f32 v151, v151, v116
  v_sub_f32 v152, v152, v118
  v_sub_f32 v153, v153, v118
  v_sub_f32 v154, v154, v118
  v_sub_f32 v155, v155, v118
  v_sub_f32 v156, v156, v118
  v_sub_f32 v157, v157, v118
  v_sub_f32 v158, v158, v118
  v_sub_f32 v159, v159, v118
  v_exp_f32 v128, v128
  v_exp_f32 v129, v129
  v_exp_f32 v130, v130
  v_exp_f32 v131, v131
  v_exp_f32 v132, v132
  v_exp_f32 v133, v133
  v_exp_f32 v134, v134
  v_exp_f32 v135, v135
  v_exp_f32 v136, v136
  v_exp_f32 v137, v137
  v_exp_f32 v138, v138
  v_exp_f32 v139, v139
  v_exp_f32 v140, v140
  v_exp_f32 v141, v141
  v_exp_f32 v142, v142
  v_exp_f32 v143, v143
  v_exp_f32 v144, v144
  v_exp_f32 v145, v145
  v_exp_f32 v146, v146
  v_exp_f32 v147, v147
  v_exp_f32 v148, v148
  v_exp_f32 v149, v149
  v_exp_f32 v150, v150
  v_exp_f32 v151, v151
  v_exp_f32 v152, v152
  v_exp_f32 v153, v153
  v_exp_f32 v154, v154
  v_exp_f32 v155, v155
  v_exp_f32 v156, v156
  v_exp_f32 v157, v157
  v_exp_f32 v158, v158
  v_exp_f32 v159, v159
  v_add_f32 v112, v128, v129
  v_add_f32 v113, v130, v131
  v_add_f32 v114, v136, v137
  v_add_f32 v115, v138, v139
  v_add_f32 v112, v112, v132
  v_add_f32 v114, v114, v140
  v_add_f32 v113, v113, v133
  v_add_f32 v115, v115, v141
  v_add_f32 v112, v112, v134
  v_add_f32 v114, v114, v142
  v_add_f32 v113, v113, v135
  v_add_f32 v115, v115, v143
  v_add_f32 v112, v112, v113
  v_add_f32 v114, v114, v115
  v_add_f32 v116, v144, v145
  v_add_f32 v117, v146, v147
  v_add_f32 v118, v152, v153
  v_add_f32 v119, v154, v155
  v_add_f32 v116, v116, v148
  v_add_f32 v118, v118, v156
  v_add_f32 v117, v117, v149
  v_add_f32 v119, v119, v157
  v_add_f32 v116, v116, v150
  v_add_f32 v118, v118, v158
  v_add_f32 v117, v117, v151
  v_add_f32 v119, v119, v159
  v_add_f32 v116, v116, v117
  v_add_f32 v118, v118, v119
  v_permlane32_swap_b32 v112, v114
  s_nop 0
  v_permlane32_swap_b32 v116, v118
  v_add_f32 v112, v112, v114
  v_add_f32 v116, v116, v118
  v_rcp_f32 v114, v112
  v_rcp_f32 v118, v116
  s_branch L_fb15_r
.section .rodata,"a"
.p2align 6
.amdhsa_kernel gated_mix__linear_kernel_hedgehog__sliding_block__prompt_kernel
  .amdhsa_next_free_vgpr 256
  .amdhsa_next_free_sgpr 102
  .amdhsa_accum_offset 256
  .amdhsa_group_segment_fixed_size 0
  .amdhsa_kernarg_size 88
  .amdhsa_user_sgpr_count 2
  .amdhsa_user_sgpr_kernarg_segment_ptr 1
  .amdhsa_system_sgpr_workgroup_id_x 1
.end_amdhsa_kernel
```
